```python
import torch

def _softmax(x, axis=-1):
    return torch.softmax(x, dim=axis)
def _gelu(x):
    return torch.nn.functional.gelu(x, approximate="tanh")
def _silu(x):
    return torch.nn.functional.silu(x)
def _sigmoid(x):
    return torch.sigmoid(x)
def _layernorm(x, axis=-1, eps=1e-5):
    m = x.mean(dim=axis, keepdim=True)
    v = x.var(dim=axis, keepdim=True, unbiased=False)
    return (x - m) / torch.sqrt(v + eps)
def _scatter_add(tgt, idx, src, axis=0):
    return tgt.clone().index_add_(axis, idx, src)
def _segment_sum(src, seg, n):
    out = torch.zeros((n,) + src.shape[1:], dtype=src.dtype)
    return out.index_add_(0, seg, src)
def _pad(x, pw):
    flat = tuple(v for pair in reversed(pw) for v in pair)
    return torch.nn.functional.pad(x, flat)

kernel_name = 'sequential_preLN__mha_block_cached__dense_activation_silu__decode'

def setup_inputs():

    _w = (lambda a: (lambda t: t.to(torch.bfloat16) if t.is_floating_point() else t)(torch.as_tensor(a)))
    def _A_setup():
        B, Sq, D = 1, 1, 512
        H, Sk, Dh = 32, 16384, 128
        return {
            "x": _w((lambda *s: torch.randn(*s, dtype=torch.bfloat16) * 0.1)(B, Sq, D)),
            "k_cache": _w((lambda *s: torch.randn(*s, dtype=torch.bfloat16) * 1.6)(B, H, Sk, Dh)),
            "v_cache": _w((lambda *s: torch.randn(*s, dtype=torch.bfloat16) * 1.6)(B, H, Sk, Dh)),
            "wq": _w((lambda *s: torch.randn(*s, dtype=torch.bfloat16) * 1.6)(D, H * Dh) * (D ** -0.5)),
            "wo": _w((lambda *s: torch.randn(*s, dtype=torch.bfloat16) * 1.6)(H * Dh, D) * ((H * Dh) ** -0.5)),
        }
    _A_in = _A_setup()

    def _B_setup():
        B, S, D, F = 1, 1, 512, 1792
        return {
            "x": _w((lambda *s: torch.randn(*s, dtype=torch.bfloat16) * 0.1)(B, S, D)),
            "w1": _w((lambda *s: torch.randn(*s, dtype=torch.bfloat16) * 3.2)(D, F) * (D ** -0.5)),
            "w2": _w((lambda *s: torch.randn(*s, dtype=torch.bfloat16) * 3.2)(F, D) * (F ** -0.5)),
        }
    _B_in = _B_setup()

    return {
        "A_x": _A_in["x"],
        "A_k_cache": _A_in["k_cache"],
        "A_v_cache": _A_in["v_cache"],
        "A_wq": _A_in["wq"],
        "A_wo": _A_in["wo"],
        "B_x": _B_in["x"],
        "B_w1": _B_in["w1"],
        "B_w2": _B_in["w2"],
    }

def reference(A_x, A_k_cache, A_v_cache, A_wq, A_wo, B_x, B_w1, B_w2):
    def _A_ref(x, k_cache, v_cache, wq, wo):
        B, Sq, D = x.shape
        H, Dh = 32, 128
        q = (lambda x, *d: x.permute(*d))((x @ wq).reshape(B, Sq, H, Dh), 0, 2, 1, 3)
        scores = torch.einsum("bhqd,bhkd->bhqk", q, k_cache) * (Dh ** -0.5)
        p = _softmax(scores, axis=-1)
        o = torch.einsum("bhqk,bhkd->bhqd", p, v_cache)
        return (lambda x, *d: x.permute(*d))(o, 0, 2, 1, 3).reshape(B, Sq, H * Dh) @ wo

    def _B_ref(x, w1, w2):
        h = torch.einsum("bsd,df->bsf", x, w1)
        h = _silu(h)
        out = torch.einsum("bsf,fd->bsd", h, w2)
        return out

    x = A_x
    h = x + _A_ref(_layernorm(x, axis=-1), A_k_cache, A_v_cache, A_wq, A_wo)
    h2 = h + _B_ref(_layernorm(h, axis=-1), B_w1, B_w2)
    return h2
```

```asm
; @launch grid=(256,1,1) block=(512,1,1) lds=73728
.amdgcn_target "amdgcn-amd-amdhsa--gfx950"
.text
.globl sequential_preLN__mha_block_cached__dense_activation_silu__decode_kernel
.p2align 8
.type sequential_preLN__mha_block_cached__dense_activation_silu__decode_kernel,@function
sequential_preLN__mha_block_cached__dense_activation_silu__decode_kernel:
    s_cmp_ge_u32 s2, 256
    s_cbranch_scc1 L_end
    s_cmp_lt_u32 s2, 8
    s_cbranch_scc0 L_nocpfe
    s_getpc_b64 s[44:45]
L_pce:
    s_mov_b32 s46, L_codeend-L_pce
    s_mov_b32 s47, 0x20000
    v_lshlrev_b32 v2, 6, v0
    buffer_load_dword v59, v2, s[44:47], 0 offen
L_nocpfe:
    s_load_dwordx16 s[4:19], s[0:1], 0
    s_load_dwordx4 s[20:23], s[0:1], 64
    s_load_dwordx2 s[24:25], s[0:1], 80
    v_lshrrev_b32 v1, 6, v0
    v_and_b32 v0, 63, v0
    v_readfirstlane_b32 s3, v1
    s_and_b32 s26, s2, 31
    s_lshr_b32 s27, s2, 5
    s_bfe_u32 s91, s26, 0x10000
    s_bfe_u32 s90, s26, 0x20003
    s_lshl_b32 s90, s90, 1
    s_or_b32 s91, s91, s90
    s_bfe_u32 s90, s26, 0x10002
    s_lshl_b32 s90, s90, 3
    s_or_b32 s91, s91, s90
    s_bfe_u32 s90, s26, 0x10001
    s_lshl_b32 s90, s90, 4
    s_or_b32 s91, s91, s90
    s_cmp_ge_u32 s3, 4
    s_cbranch_scc1 L_T
    v_lshlrev_b32 v1, 10, v1
    v_lshl_add_u32 v1, v0, 4, v1
    s_lshl_b32 s34, s91, 22
    s_lshl_b32 s35, s27, 19
    s_mov_b32 s30, 0x80000
    s_add_u32 s34, s34, s35
    s_mov_b32 s31, 0x20000
    s_bfe_u32 s49, s2, 0x10005
    s_lshl_b32 s49, s49, 5
    s_bfe_u32 s48, s2, 0x10005
    s_lshl_b32 s48, s48, 6
    s_xor_b32 s49, s49, s48
    s_bfe_u32 s48, s2, 0x10006
    s_lshl_b32 s48, s48, 6
    s_xor_b32 s49, s49, s48
    s_lshl_b32 s48, s49, 12
    s_waitcnt lgkmcnt(0)
    s_add_u32 s28, s6, s34
    s_addc_u32 s29, s7, 0
    s_add_u32 s32, s8, s34
    s_addc_u32 s33, s9, 0
    s_mov_b32 s34, s48
    buffer_load_dwordx4 v[64:67], v1, s[28:31], s34 offen nt
    s_add_u32 s34, s34, 4096
    buffer_load_dwordx4 v[68:71], v1, s[28:31], s34 offen nt
    s_add_u32 s34, s34, 4096
    buffer_load_dwordx4 v[72:75], v1, s[28:31], s34 offen nt
    s_add_u32 s34, s34, 4096
    buffer_load_dwordx4 v[76:79], v1, s[28:31], s34 offen nt
    s_add_u32 s34, s34, 4096
    buffer_load_dwordx4 v[80:83], v1, s[28:31], s34 offen nt
    s_add_u32 s34, s34, 4096
    buffer_load_dwordx4 v[84:87], v1, s[28:31], s34 offen nt
    s_add_u32 s34, s34, 4096
    v_and_b32 v46, 1, v0
    v_lshlrev_b32 v46, 4, v46
    v_mov_b32 v47, 0xffff
    v_lshlrev_b32 v46, v46, v47
    v_bfe_u32 v47, v0, 1, 3
    v_cmp_eq_u32 vcc, 0, v47
    s_nop 1
    v_cndmask_b32 v6, 0, v46, vcc
    v_cmp_eq_u32 vcc, 1, v47
    s_nop 1
    v_cndmask_b32 v7, 0, v46, vcc
    v_cmp_eq_u32 vcc, 2, v47
    s_nop 1
    v_cndmask_b32 v8, 0, v46, vcc
    v_cmp_eq_u32 vcc, 3, v47
    s_nop 1
    v_cndmask_b32 v9, 0, v46, vcc
    s_mov_b32 s36, 0xcccccccc
    s_mov_b32 s37, 0xcccccccc
    s_mov_b32 s38, 0xaaaaaaaa
    s_mov_b32 s39, 0xaaaaaaaa
    v_and_b32 v46, 15, v0
    v_lshlrev_b32 v46, 5, v46
    v_lshrrev_b32 v52, 1, v46
    v_lshrrev_b32 v50, 4, v0
    v_lshl_add_u32 v50, v50, 4, v46
    s_lshl_b32 s40, s3, 9
    v_add_u32 v50, s40, v50
    v_mov_b32 v42, 0
    v_mov_b32 v43, 0
    v_mov_b32 v44, 0
    v_mov_b32 v45, 0
    s_waitcnt vmcnt(5)
    buffer_load_dwordx4 v[88:91], v1, s[28:31], s34 offen nt
    s_add_u32 s34, s34, 4096
    s_waitcnt vmcnt(5)
    buffer_load_dwordx4 v[92:95], v1, s[28:31], s34 offen nt
    s_add_u32 s34, s34, 4096
    s_waitcnt vmcnt(5)
    buffer_load_dwordx4 v[96:99], v1, s[28:31], s34 offen nt
    s_add_u32 s34, s34, 4096
    s_waitcnt vmcnt(5)
    buffer_load_dwordx4 v[100:103], v1, s[28:31], s34 offen nt
    s_add_u32 s34, s34, 4096
    s_waitcnt vmcnt(5)
    buffer_load_dwordx4 v[104:107], v1, s[28:31], s34 offen nt
    s_add_u32 s34, s34, 4096
    s_waitcnt vmcnt(5)
    buffer_load_dwordx4 v[108:111], v1, s[28:31], s34 offen nt
    s_add_u32 s34, s34, 4096
    s_waitcnt vmcnt(5)
    buffer_load_dwordx4 v[112:115], v1, s[28:31], s34 offen nt
    s_add_u32 s34, s34, 4096
    s_waitcnt vmcnt(5)
    buffer_load_dwordx4 v[116:119], v1, s[28:31], s34 offen nt
    s_add_u32 s34, s34, 4096
    s_waitcnt vmcnt(5)
    buffer_load_dwordx4 v[120:123], v1, s[28:31], s34 offen nt
    s_add_u32 s34, s34, 4096
    s_waitcnt vmcnt(5)
    buffer_load_dwordx4 v[124:127], v1, s[28:31], s34 offen nt
    s_add_u32 s34, s34, 4096
    s_waitcnt vmcnt(5)
    buffer_load_dwordx4 v[128:131], v1, s[28:31], s34 offen nt
    s_add_u32 s34, s34, 4096
    s_waitcnt vmcnt(5)
    buffer_load_dwordx4 v[132:135], v1, s[28:31], s34 offen nt
    s_add_u32 s34, s34, 4096
    s_waitcnt vmcnt(5)
    buffer_load_dwordx4 v[136:139], v1, s[28:31], s34 offen nt
    s_add_u32 s34, s34, 4096
    s_waitcnt vmcnt(5)
    buffer_load_dwordx4 v[140:143], v1, s[28:31], s34 offen nt
    s_add_u32 s34, s34, 4096
    s_waitcnt vmcnt(5)
    buffer_load_dwordx4 v[144:147], v1, s[28:31], s34 offen nt
    s_add_u32 s34, s34, 4096
    s_waitcnt vmcnt(5)
    buffer_load_dwordx4 v[148:151], v1, s[28:31], s34 offen nt
    s_add_u32 s34, s34, 4096
    s_waitcnt vmcnt(5)
    buffer_load_dwordx4 v[152:155], v1, s[28:31], s34 offen nt
    s_add_u32 s34, s34, 4096
    s_waitcnt vmcnt(5)
    buffer_load_dwordx4 v[156:159], v1, s[28:31], s34 offen nt
    s_add_u32 s34, s34, 4096
    s_waitcnt vmcnt(5)
    buffer_load_dwordx4 v[160:163], v1, s[28:31], s34 offen nt
    s_add_u32 s34, s34, 4096
    s_waitcnt vmcnt(5)
    buffer_load_dwordx4 v[164:167], v1, s[28:31], s34 offen nt
    s_add_u32 s34, s34, 4096
    s_waitcnt vmcnt(5)
    buffer_load_dwordx4 v[168:171], v1, s[28:31], s34 offen nt
    s_add_u32 s34, s34, 4096
    s_waitcnt vmcnt(5)
    buffer_load_dwordx4 v[172:175], v1, s[28:31], s34 offen nt
    s_add_u32 s34, s34, 4096
    s_waitcnt vmcnt(5)
    buffer_load_dwordx4 v[176:179], v1, s[28:31], s34 offen nt
    s_add_u32 s34, s34, 4096
    s_waitcnt vmcnt(5)
    buffer_load_dwordx4 v[180:183], v1, s[28:31], s34 offen nt
    s_add_u32 s34, s34, 4096
    s_waitcnt vmcnt(5)
    buffer_load_dwordx4 v[184:187], v1, s[28:31], s34 offen nt
    s_add_u32 s34, s34, 4096
    s_waitcnt vmcnt(5)
    buffer_load_dwordx4 v[188:191], v1, s[28:31], s34 offen nt
    s_add_u32 s34, s34, 4096
    s_and_b32 s34, s34, 0x7ffff
    s_barrier
    ds_read_b128 v[2:5], v52 offset:0
    s_waitcnt lgkmcnt(0)
    s_mov_b32 s35, 0
    s_getreg_b32 s40, hwreg(HW_REG_XCC_ID, 0, 3)
    s_lshr_b32 s40, 85, s40
    s_and_b32 vcc_lo, s40, 1
    s_mov_b32 vcc_hi, 0
L_kloop:
    s_cmp_eq_u32 s35, 3
    s_cselect_b32 s28, s32, s28
    s_cselect_b32 s29, s33, s29
    s_waitcnt vmcnt(15)
    s_cbranch_vccz L_dw1
    s_waitcnt vmcnt(6)
L_dw1:
    v_dot2_f32_bf16 v18, v64, v2, 0
    v_dot2_f32_bf16 v18, v65, v3, v18
    v_dot2_f32_bf16 v18, v66, v4, v18
    v_dot2_f32_bf16 v18, v67, v5, v18
    buffer_load_dwordx4 v[64:67], v1, s[28:31], s34 offen nt
    s_add_u32 s34, s34, 4096
    s_waitcnt vmcnt(15)
    s_cbranch_vccz L_dw2
    s_waitcnt vmcnt(6)
L_dw2:
    v_dot2_f32_bf16 v19, v68, v2, 0
    v_dot2_f32_bf16 v19, v69, v3, v19
    v_dot2_f32_bf16 v19, v70, v4, v19
    v_dot2_f32_bf16 v19, v71, v5, v19
    buffer_load_dwordx4 v[68:71], v1, s[28:31], s34 offen nt
    s_add_u32 s34, s34, 4096
    s_waitcnt vmcnt(15)
    s_cbranch_vccz L_dw3
    s_waitcnt vmcnt(5)
L_dw3:
    v_dot2_f32_bf16 v20, v72, v2, 0
    v_dot2_f32_bf16 v20, v73, v3, v20
    v_dot2_f32_bf16 v20, v74, v4, v20
    v_dot2_f32_bf16 v20, v75, v5, v20
    buffer_load_dwordx4 v[72:75], v1, s[28:31], s34 offen nt
    s_add_u32 s34, s34, 4096
    s_waitcnt vmcnt(15)
    s_cbranch_vccz L_dw4
    s_waitcnt vmcnt(6)
L_dw4:
    v_dot2_f32_bf16 v21, v76, v2, 0
    v_dot2_f32_bf16 v21, v77, v3, v21
    v_dot2_f32_bf16 v21, v78, v4, v21
    v_dot2_f32_bf16 v21, v79, v5, v21
    buffer_load_dwordx4 v[76:79], v1, s[28:31], s34 offen nt
    s_add_u32 s34, s34, 4096
    s_waitcnt vmcnt(15)
    s_cbranch_vccz L_dw5
    s_waitcnt vmcnt(6)
L_dw5:
    v_dot2_f32_bf16 v22, v80, v2, 0
    v_dot2_f32_bf16 v22, v81, v3, v22
    v_dot2_f32_bf16 v22, v82, v4, v22
    v_dot2_f32_bf16 v22, v83, v5, v22
    buffer_load_dwordx4 v[80:83], v1, s[28:31], s34 offen nt
    s_add_u32 s34, s34, 4096
    s_waitcnt vmcnt(15)
    s_cbranch_vccz L_dw6
    s_waitcnt vmcnt(6)
L_dw6:
    v_dot2_f32_bf16 v23, v84, v2, 0
    v_dot2_f32_bf16 v23, v85, v3, v23
    v_dot2_f32_bf16 v23, v86, v4, v23
    v_dot2_f32_bf16 v23, v87, v5, v23
    buffer_load_dwordx4 v[84:87], v1, s[28:31], s34 offen nt
    s_add_u32 s34, s34, 4096
    s_waitcnt vmcnt(15)
    s_cbranch_vccz L_dw7
    s_waitcnt vmcnt(5)
L_dw7:
    v_dot2_f32_bf16 v24, v88, v2, 0
    v_dot2_f32_bf16 v24, v89, v3, v24
    v_dot2_f32_bf16 v24, v90, v4, v24
    v_dot2_f32_bf16 v24, v91, v5, v24
    buffer_load_dwordx4 v[88:91], v1, s[28:31], s34 offen nt
    s_add_u32 s34, s34, 4096
    s_waitcnt vmcnt(15)
    s_cbranch_vccz L_dw8
    s_waitcnt vmcnt(6)
L_dw8:
    v_dot2_f32_bf16 v25, v92, v2, 0
    v_dot2_f32_bf16 v25, v93, v3, v25
    v_dot2_f32_bf16 v25, v94, v4, v25
    v_dot2_f32_bf16 v25, v95, v5, v25
    buffer_load_dwordx4 v[92:95], v1, s[28:31], s34 offen nt
    s_add_u32 s34, s34, 4096
    s_waitcnt vmcnt(15)
    s_cbranch_vccz L_dw9
    s_waitcnt vmcnt(6)
L_dw9:
    v_dot2_f32_bf16 v26, v96, v2, 0
    v_dot2_f32_bf16 v26, v97, v3, v26
    v_dot2_f32_bf16 v26, v98, v4, v26
    v_dot2_f32_bf16 v26, v99, v5, v26
    buffer_load_dwordx4 v[96:99], v1, s[28:31], s34 offen nt
    s_add_u32 s34, s34, 4096
    s_waitcnt vmcnt(15)
    s_cbranch_vccz L_dw10
    s_waitcnt vmcnt(6)
L_dw10:
    v_dot2_f32_bf16 v27, v100, v2, 0
    v_dot2_f32_bf16 v27, v101, v3, v27
    v_dot2_f32_bf16 v27, v102, v4, v27
    v_dot2_f32_bf16 v27, v103, v5, v27
    buffer_load_dwordx4 v[100:103], v1, s[28:31], s34 offen nt
    s_add_u32 s34, s34, 4096
    s_waitcnt vmcnt(15)
    s_cbranch_vccz L_dw11
    s_waitcnt vmcnt(5)
L_dw11:
    v_dot2_f32_bf16 v28, v104, v2, 0
    v_dot2_f32_bf16 v28, v105, v3, v28
    v_dot2_f32_bf16 v28, v106, v4, v28
    v_dot2_f32_bf16 v28, v107, v5, v28
    buffer_load_dwordx4 v[104:107], v1, s[28:31], s34 offen nt
    s_add_u32 s34, s34, 4096
    s_waitcnt vmcnt(15)
    s_cbranch_vccz L_dw12
    s_waitcnt vmcnt(6)
L_dw12:
    v_dot2_f32_bf16 v29, v108, v2, 0
    v_dot2_f32_bf16 v29, v109, v3, v29
    v_dot2_f32_bf16 v29, v110, v4, v29
    v_dot2_f32_bf16 v29, v111, v5, v29
    buffer_load_dwordx4 v[108:111], v1, s[28:31], s34 offen nt
    s_add_u32 s34, s34, 4096
    s_waitcnt vmcnt(15)
    s_cbranch_vccz L_dw13
    s_waitcnt vmcnt(6)
L_dw13:
    v_dot2_f32_bf16 v30, v112, v2, 0
    v_dot2_f32_bf16 v30, v113, v3, v30
    v_dot2_f32_bf16 v30, v114, v4, v30
    v_dot2_f32_bf16 v30, v115, v5, v30
    buffer_load_dwordx4 v[112:115], v1, s[28:31], s34 offen nt
    s_add_u32 s34, s34, 4096
    s_waitcnt vmcnt(15)
    s_cbranch_vccz L_dw14
    s_waitcnt vmcnt(6)
L_dw14:
    v_dot2_f32_bf16 v31, v116, v2, 0
    v_dot2_f32_bf16 v31, v117, v3, v31
    v_dot2_f32_bf16 v31, v118, v4, v31
    v_dot2_f32_bf16 v31, v119, v5, v31
    buffer_load_dwordx4 v[116:119], v1, s[28:31], s34 offen nt
    s_add_u32 s34, s34, 4096
    s_waitcnt vmcnt(15)
    s_cbranch_vccz L_dw15
    s_waitcnt vmcnt(5)
L_dw15:
    v_dot2_f32_bf16 v32, v120, v2, 0
    v_dot2_f32_bf16 v32, v121, v3, v32
    v_dot2_f32_bf16 v32, v122, v4, v32
    v_dot2_f32_bf16 v32, v123, v5, v32
    buffer_load_dwordx4 v[120:123], v1, s[28:31], s34 offen nt
    s_add_u32 s34, s34, 4096
    s_waitcnt vmcnt(15)
    s_cbranch_vccz L_dw16
    s_waitcnt vmcnt(6)
L_dw16:
    v_dot2_f32_bf16 v33, v124, v2, 0
    v_dot2_f32_bf16 v33, v125, v3, v33
    v_dot2_f32_bf16 v33, v126, v4, v33
    v_dot2_f32_bf16 v33, v127, v5, v33
    buffer_load_dwordx4 v[124:127], v1, s[28:31], s34 offen nt
    s_add_u32 s34, s34, 4096
    v_add_f32_dpp v18, v18, v18 row_mirror row_mask:0xf bank_mask:0x3
    v_add_f32_dpp v19, v19, v19 row_mirror row_mask:0xf bank_mask:0x3
    v_add_f32_dpp v20, v20, v20 row_mirror row_mask:0xf bank_mask:0x3
    v_add_f32_dpp v21, v21, v21 row_mirror row_mask:0xf bank_mask:0x3
    v_add_f32_dpp v22, v22, v22 row_mirror row_mask:0xf bank_mask:0x3
    v_add_f32_dpp v23, v23, v23 row_mirror row_mask:0xf bank_mask:0x3
    v_add_f32_dpp v24, v24, v24 row_mirror row_mask:0xf bank_mask:0x3
    v_add_f32_dpp v25, v25, v25 row_mirror row_mask:0xf bank_mask:0x3
    v_add_f32_dpp v18, v26, v26 row_mirror row_mask:0xf bank_mask:0xc
    v_add_f32_dpp v19, v27, v27 row_mirror row_mask:0xf bank_mask:0xc
    v_add_f32_dpp v20, v28, v28 row_mirror row_mask:0xf bank_mask:0xc
    v_add_f32_dpp v21, v29, v29 row_mirror row_mask:0xf bank_mask:0xc
    v_add_f32_dpp v22, v30, v30 row_mirror row_mask:0xf bank_mask:0xc
    v_add_f32_dpp v23, v31, v31 row_mirror row_mask:0xf bank_mask:0xc
    v_add_f32_dpp v24, v32, v32 row_mirror row_mask:0xf bank_mask:0xc
    v_add_f32_dpp v25, v33, v33 row_mirror row_mask:0xf bank_mask:0xc
    v_add_f32_dpp v18, v18, v18 row_half_mirror row_mask:0xf bank_mask:0x5
    v_add_f32_dpp v19, v19, v19 row_half_mirror row_mask:0xf bank_mask:0x5
    v_add_f32_dpp v20, v20, v20 row_half_mirror row_mask:0xf bank_mask:0x5
    v_add_f32_dpp v21, v21, v21 row_half_mirror row_mask:0xf bank_mask:0x5
    v_add_f32_dpp v18, v22, v22 row_half_mirror row_mask:0xf bank_mask:0xa
    v_add_f32_dpp v19, v23, v23 row_half_mirror row_mask:0xf bank_mask:0xa
    v_add_f32_dpp v20, v24, v24 row_half_mirror row_mask:0xf bank_mask:0xa
    v_add_f32_dpp v21, v25, v25 row_half_mirror row_mask:0xf bank_mask:0xa
    v_add_f32_dpp v18, v18, v18 quad_perm:[2,3,0,1] row_mask:0xf bank_mask:0xf
    v_add_f32_dpp v19, v19, v19 quad_perm:[2,3,0,1] row_mask:0xf bank_mask:0xf
    v_add_f32_dpp v20, v20, v20 quad_perm:[2,3,0,1] row_mask:0xf bank_mask:0xf
    v_add_f32_dpp v21, v21, v21 quad_perm:[2,3,0,1] row_mask:0xf bank_mask:0xf
    v_cndmask_b32 v18, v18, v20, s[36:37]
    v_cndmask_b32 v19, v19, v21, s[36:37]
    s_nop 0
    v_add_f32_dpp v18, v18, v18 quad_perm:[1,0,3,2] row_mask:0xf bank_mask:0xf
    v_add_f32_dpp v19, v19, v19 quad_perm:[1,0,3,2] row_mask:0xf bank_mask:0xf
    v_mov_b32 v10, v12
    v_mov_b32 v11, v13
    v_mov_b32 v12, v14
    v_mov_b32 v13, v15
    v_mov_b32 v14, v16
    v_mov_b32 v15, v17
    v_cndmask_b32 v16, v18, v19, s[38:39]
    s_waitcnt vmcnt(15)
    s_cbranch_vccz L_dw17
    s_waitcnt vmcnt(6)
L_dw17:
    v_dot2_f32_bf16 v18, v128, v2, 0
    v_dot2_f32_bf16 v18, v129, v3, v18
    v_dot2_f32_bf16 v18, v130, v4, v18
    v_dot2_f32_bf16 v18, v131, v5, v18
    buffer_load_dwordx4 v[128:131], v1, s[28:31], s34 offen nt
    s_add_u32 s34, s34, 4096
    s_waitcnt vmcnt(15)
    s_cbranch_vccz L_dw18
    s_waitcnt vmcnt(6)
L_dw18:
    v_dot2_f32_bf16 v19, v132, v2, 0
    v_dot2_f32_bf16 v19, v133, v3, v19
    v_dot2_f32_bf16 v19, v134, v4, v19
    v_dot2_f32_bf16 v19, v135, v5, v19
    buffer_load_dwordx4 v[132:135], v1, s[28:31], s34 offen nt
    s_add_u32 s34, s34, 4096
    s_waitcnt vmcnt(15)
    s_cbranch_vccz L_dw19
    s_waitcnt vmcnt(5)
L_dw19:
    v_dot2_f32_bf16 v20, v136, v2, 0
    v_dot2_f32_bf16 v20, v137, v3, v20
    v_dot2_f32_bf16 v20, v138, v4, v20
    v_dot2_f32_bf16 v20, v139, v5, v20
    buffer_load_dwordx4 v[136:139], v1, s[28:31], s34 offen nt
    s_add_u32 s34, s34, 4096
    s_waitcnt vmcnt(15)
    s_cbranch_vccz L_dw20
    s_waitcnt vmcnt(6)
L_dw20:
    v_dot2_f32_bf16 v21, v140, v2, 0
    v_dot2_f32_bf16 v21, v141, v3, v21
    v_dot2_f32_bf16 v21, v142, v4, v21
    v_dot2_f32_bf16 v21, v143, v5, v21
    buffer_load_dwordx4 v[140:143], v1, s[28:31], s34 offen nt
    s_add_u32 s34, s34, 4096
    s_waitcnt vmcnt(15)
    s_cbranch_vccz L_dw21
    s_waitcnt vmcnt(6)
L_dw21:
    v_dot2_f32_bf16 v22, v144, v2, 0
    v_dot2_f32_bf16 v22, v145, v3, v22
    v_dot2_f32_bf16 v22, v146, v4, v22
    v_dot2_f32_bf16 v22, v147, v5, v22
    buffer_load_dwordx4 v[144:147], v1, s[28:31], s34 offen nt
    s_add_u32 s34, s34, 4096
    s_waitcnt vmcnt(15)
    s_cbranch_vccz L_dw22
    s_waitcnt vmcnt(6)
L_dw22:
    v_dot2_f32_bf16 v23, v148, v2, 0
    v_dot2_f32_bf16 v23, v149, v3, v23
    v_dot2_f32_bf16 v23, v150, v4, v23
    v_dot2_f32_bf16 v23, v151, v5, v23
    buffer_load_dwordx4 v[148:151], v1, s[28:31], s34 offen nt
    s_add_u32 s34, s34, 4096
    s_waitcnt vmcnt(15)
    s_cbranch_vccz L_dw23
    s_waitcnt vmcnt(5)
L_dw23:
    v_dot2_f32_bf16 v24, v152, v2, 0
    v_dot2_f32_bf16 v24, v153, v3, v24
    v_dot2_f32_bf16 v24, v154, v4, v24
    v_dot2_f32_bf16 v24, v155, v5, v24
    buffer_load_dwordx4 v[152:155], v1, s[28:31], s34 offen nt
    s_add_u32 s34, s34, 4096
    s_waitcnt vmcnt(15)
    s_cbranch_vccz L_dw24
    s_waitcnt vmcnt(6)
L_dw24:
    v_dot2_f32_bf16 v25, v156, v2, 0
    v_dot2_f32_bf16 v25, v157, v3, v25
    v_dot2_f32_bf16 v25, v158, v4, v25
    v_dot2_f32_bf16 v25, v159, v5, v25
    buffer_load_dwordx4 v[156:159], v1, s[28:31], s34 offen nt
    s_add_u32 s34, s34, 4096
    s_waitcnt vmcnt(15)
    s_cbranch_vccz L_dw25
    s_waitcnt vmcnt(6)
L_dw25:
    v_dot2_f32_bf16 v26, v160, v2, 0
    v_dot2_f32_bf16 v26, v161, v3, v26
    v_dot2_f32_bf16 v26, v162, v4, v26
    v_dot2_f32_bf16 v26, v163, v5, v26
    buffer_load_dwordx4 v[160:163], v1, s[28:31], s34 offen nt
    s_add_u32 s34, s34, 4096
    s_waitcnt vmcnt(15)
    s_cbranch_vccz L_dw26
    s_waitcnt vmcnt(6)
L_dw26:
    v_dot2_f32_bf16 v27, v164, v2, 0
    v_dot2_f32_bf16 v27, v165, v3, v27
    v_dot2_f32_bf16 v27, v166, v4, v27
    v_dot2_f32_bf16 v27, v167, v5, v27
    buffer_load_dwordx4 v[164:167], v1, s[28:31], s34 offen nt
    s_add_u32 s34, s34, 4096
    s_waitcnt vmcnt(15)
    s_cbranch_vccz L_dw27
    s_waitcnt vmcnt(5)
L_dw27:
    v_dot2_f32_bf16 v28, v168, v2, 0
    v_dot2_f32_bf16 v28, v169, v3, v28
    v_dot2_f32_bf16 v28, v170, v4, v28
    v_dot2_f32_bf16 v28, v171, v5, v28
    buffer_load_dwordx4 v[168:171], v1, s[28:31], s34 offen nt
    s_add_u32 s34, s34, 4096
    s_waitcnt vmcnt(15)
    s_cbranch_vccz L_dw28
    s_waitcnt vmcnt(6)
L_dw28:
    v_dot2_f32_bf16 v29, v172, v2, 0
    v_dot2_f32_bf16 v29, v173, v3, v29
    v_dot2_f32_bf16 v29, v174, v4, v29
    v_dot2_f32_bf16 v29, v175, v5, v29
    buffer_load_dwordx4 v[172:175], v1, s[28:31], s34 offen nt
    s_add_u32 s34, s34, 4096
    s_waitcnt vmcnt(15)
    s_cbranch_vccz L_dw29
    s_waitcnt vmcnt(6)
L_dw29:
    v_dot2_f32_bf16 v30, v176, v2, 0
    v_dot2_f32_bf16 v30, v177, v3, v30
    v_dot2_f32_bf16 v30, v178, v4, v30
    v_dot2_f32_bf16 v30, v179, v5, v30
    buffer_load_dwordx4 v[176:179], v1, s[28:31], s34 offen nt
    s_add_u32 s34, s34, 4096
    s_waitcnt vmcnt(15)
    s_cbranch_vccz L_dw30
    s_waitcnt vmcnt(6)
L_dw30:
    v_dot2_f32_bf16 v31, v180, v2, 0
    v_dot2_f32_bf16 v31, v181, v3, v31
    v_dot2_f32_bf16 v31, v182, v4, v31
    v_dot2_f32_bf16 v31, v183, v5, v31
    buffer_load_dwordx4 v[180:183], v1, s[28:31], s34 offen nt
    s_add_u32 s34, s34, 4096
    s_waitcnt vmcnt(15)
    s_cbranch_vccz L_dw31
    s_waitcnt vmcnt(5)
L_dw31:
    v_dot2_f32_bf16 v32, v184, v2, 0
    v_dot2_f32_bf16 v32, v185, v3, v32
    v_dot2_f32_bf16 v32, v186, v4, v32
    v_dot2_f32_bf16 v32, v187, v5, v32
    buffer_load_dwordx4 v[184:187], v1, s[28:31], s34 offen nt
    s_add_u32 s34, s34, 4096
    s_waitcnt vmcnt(15)
    s_cbranch_vccz L_dw32
    s_waitcnt vmcnt(6)
L_dw32:
    v_dot2_f32_bf16 v33, v188, v2, 0
    v_dot2_f32_bf16 v33, v189, v3, v33
    v_dot2_f32_bf16 v33, v190, v4, v33
    v_dot2_f32_bf16 v33, v191, v5, v33
    buffer_load_dwordx4 v[188:191], v1, s[28:31], s34 offen nt
    s_add_u32 s34, s34, 4096
    s_and_b32 s34, s34, 0x7ffff
    v_add_f32_dpp v18, v18, v18 row_mirror row_mask:0xf bank_mask:0x3
    v_add_f32_dpp v19, v19, v19 row_mirror row_mask:0xf bank_mask:0x3
    v_add_f32_dpp v20, v20, v20 row_mirror row_mask:0xf bank_mask:0x3
    v_add_f32_dpp v21, v21, v21 row_mirror row_mask:0xf bank_mask:0x3
    v_add_f32_dpp v22, v22, v22 row_mirror row_mask:0xf bank_mask:0x3
    v_add_f32_dpp v23, v23, v23 row_mirror row_mask:0xf bank_mask:0x3
    v_add_f32_dpp v24, v24, v24 row_mirror row_mask:0xf bank_mask:0x3
    v_add_f32_dpp v25, v25, v25 row_mirror row_mask:0xf bank_mask:0x3
    v_add_f32_dpp v18, v26, v26 row_mirror row_mask:0xf bank_mask:0xc
    v_add_f32_dpp v19, v27, v27 row_mirror row_mask:0xf bank_mask:0xc
    v_add_f32_dpp v20, v28, v28 row_mirror row_mask:0xf bank_mask:0xc
    v_add_f32_dpp v21, v29, v29 row_mirror row_mask:0xf bank_mask:0xc
    v_add_f32_dpp v22, v30, v30 row_mirror row_mask:0xf bank_mask:0xc
    v_add_f32_dpp v23, v31, v31 row_mirror row_mask:0xf bank_mask:0xc
    v_add_f32_dpp v24, v32, v32 row_mirror row_mask:0xf bank_mask:0xc
    v_add_f32_dpp v25, v33, v33 row_mirror row_mask:0xf bank_mask:0xc
    v_add_f32_dpp v18, v18, v18 row_half_mirror row_mask:0xf bank_mask:0x5
    v_add_f32_dpp v19, v19, v19 row_half_mirror row_mask:0xf bank_mask:0x5
    v_add_f32_dpp v20, v20, v20 row_half_mirror row_mask:0xf bank_mask:0x5
    v_add_f32_dpp v21, v21, v21 row_half_mirror row_mask:0xf bank_mask:0x5
    v_add_f32_dpp v18, v22, v22 row_half_mirror row_mask:0xf bank_mask:0xa
    v_add_f32_dpp v19, v23, v23 row_half_mirror row_mask:0xf bank_mask:0xa
    v_add_f32_dpp v20, v24, v24 row_half_mirror row_mask:0xf bank_mask:0xa
    v_add_f32_dpp v21, v25, v25 row_half_mirror row_mask:0xf bank_mask:0xa
    v_add_f32_dpp v18, v18, v18 quad_perm:[2,3,0,1] row_mask:0xf bank_mask:0xf
    v_add_f32_dpp v19, v19, v19 quad_perm:[2,3,0,1] row_mask:0xf bank_mask:0xf
    v_add_f32_dpp v20, v20, v20 quad_perm:[2,3,0,1] row_mask:0xf bank_mask:0xf
    v_add_f32_dpp v21, v21, v21 quad_perm:[2,3,0,1] row_mask:0xf bank_mask:0xf
    v_cndmask_b32 v18, v18, v20, s[36:37]
    v_cndmask_b32 v19, v19, v21, s[36:37]
    s_nop 0
    v_add_f32_dpp v18, v18, v18 quad_perm:[1,0,3,2] row_mask:0xf bank_mask:0xf
    v_add_f32_dpp v19, v19, v19 quad_perm:[1,0,3,2] row_mask:0xf bank_mask:0xf
    v_cndmask_b32 v17, v18, v19, s[38:39]
    s_add_u32 s35, s35, 1
    s_cmp_lt_u32 s35, 4
    s_cbranch_scc1 L_kloop
    v_cvt_pk_bf16_f32 v10, v10, v10
    v_and_b32 v10, 0xffff0000, v10
    v_cvt_pk_bf16_f32 v11, v11, v11
    v_and_b32 v11, 0xffff0000, v11
    v_cvt_pk_bf16_f32 v12, v12, v12
    v_and_b32 v12, 0xffff0000, v12
    v_cvt_pk_bf16_f32 v13, v13, v13
    v_and_b32 v13, 0xffff0000, v13
    v_cvt_pk_bf16_f32 v14, v14, v14
    v_and_b32 v14, 0xffff0000, v14
    v_cvt_pk_bf16_f32 v15, v15, v15
    v_and_b32 v15, 0xffff0000, v15
    v_cvt_pk_bf16_f32 v16, v16, v16
    v_and_b32 v16, 0xffff0000, v16
    v_cvt_pk_bf16_f32 v17, v17, v17
    v_and_b32 v17, 0xffff0000, v17
    v_mul_f32 v10, 0x3db504f3, v10
    v_mul_f32 v11, 0x3db504f3, v11
    v_mul_f32 v12, 0x3db504f3, v12
    v_mul_f32 v13, 0x3db504f3, v13
    v_mul_f32 v14, 0x3db504f3, v14
    v_mul_f32 v15, 0x3db504f3, v15
    v_mul_f32 v16, 0x3db504f3, v16
    v_mul_f32 v17, 0x3db504f3, v17
    v_cvt_pk_bf16_f32 v10, v10, v10
    v_and_b32 v10, 0xffff0000, v10
    v_cvt_pk_bf16_f32 v11, v11, v11
    v_and_b32 v11, 0xffff0000, v11
    v_cvt_pk_bf16_f32 v12, v12, v12
    v_and_b32 v12, 0xffff0000, v12
    v_cvt_pk_bf16_f32 v13, v13, v13
    v_and_b32 v13, 0xffff0000, v13
    v_cvt_pk_bf16_f32 v14, v14, v14
    v_and_b32 v14, 0xffff0000, v14
    v_cvt_pk_bf16_f32 v15, v15, v15
    v_and_b32 v15, 0xffff0000, v15
    v_cvt_pk_bf16_f32 v16, v16, v16
    v_and_b32 v16, 0xffff0000, v16
    v_cvt_pk_bf16_f32 v17, v17, v17
    v_and_b32 v17, 0xffff0000, v17
    v_max3_f32 v46, v10, v11, v12
    v_max3_f32 v46, v46, v13, v14
    v_max3_f32 v46, v46, v15, v16
    v_max_f32 v46, v46, v17
    s_nop 1
    v_max_f32_dpp v46, v46, v46 quad_perm:[1,0,3,2] row_mask:0xf bank_mask:0xf
    s_nop 1
    v_max_f32_dpp v46, v46, v46 quad_perm:[2,3,0,1] row_mask:0xf bank_mask:0xf
    s_nop 1
    v_max_f32_dpp v46, v46, v46 row_half_mirror row_mask:0xf bank_mask:0xf
    s_nop 1
    v_max_f32_dpp v46, v46, v46 row_mirror row_mask:0xf bank_mask:0xf
    v_mov_b32 v48, v46
    s_nop 1
    v_permlane16_swap_b32 v46, v48
    v_max_f32 v46, v46, v48
    v_mov_b32 v48, v46
    s_nop 1
    v_permlane32_swap_b32 v46, v48
    v_max_f32 v46, v46, v48
    v_sub_f32 v10, v10, v46
    v_sub_f32 v11, v11, v46
    v_sub_f32 v12, v12, v46
    v_sub_f32 v13, v13, v46
    v_sub_f32 v14, v14, v46
    v_sub_f32 v15, v15, v46
    v_sub_f32 v16, v16, v46
    v_sub_f32 v17, v17, v46
    v_mul_f32 v10, 0x3fb8aa3b, v10
    v_mul_f32 v11, 0x3fb8aa3b, v11
    v_mul_f32 v12, 0x3fb8aa3b, v12
    v_mul_f32 v13, 0x3fb8aa3b, v13
    v_mul_f32 v14, 0x3fb8aa3b, v14
    v_mul_f32 v15, 0x3fb8aa3b, v15
    v_mul_f32 v16, 0x3fb8aa3b, v16
    v_mul_f32 v17, 0x3fb8aa3b, v17
    v_exp_f32 v10, v10
    v_exp_f32 v11, v11
    v_exp_f32 v12, v12
    v_exp_f32 v13, v13
    v_exp_f32 v14, v14
    v_exp_f32 v15, v15
    v_exp_f32 v16, v16
    v_exp_f32 v17, v17
    v_add_f32 v47, v10, v11
    v_add_f32 v47, v47, v12
    v_add_f32 v47, v47, v13
    v_add_f32 v47, v47, v14
    v_add_f32 v47, v47, v15
    v_add_f32 v47, v47, v16
    v_add_f32 v47, v47, v17
    v_cvt_pk_bf16_f32 v10, v10, v10
    v_cvt_pk_bf16_f32 v11, v11, v11
    v_cvt_pk_bf16_f32 v12, v12, v12
    v_cvt_pk_bf16_f32 v13, v13, v13
    v_cvt_pk_bf16_f32 v14, v14, v14
    v_cvt_pk_bf16_f32 v15, v15, v15
    v_cvt_pk_bf16_f32 v16, v16, v16
    v_cvt_pk_bf16_f32 v17, v17, v17
    v_add_f32_dpp v47, v47, v47 quad_perm:[1,0,3,2] row_mask:0xf bank_mask:0xf
    s_nop 1
    v_add_f32_dpp v47, v47, v47 quad_perm:[2,3,0,1] row_mask:0xf bank_mask:0xf
    s_nop 1
    v_add_f32_dpp v47, v47, v47 row_half_mirror row_mask:0xf bank_mask:0xf
    s_nop 1
    v_add_f32_dpp v47, v47, v47 row_mirror row_mask:0xf bank_mask:0xf
    v_mov_b32 v48, v47
    s_nop 1
    v_permlane16_swap_b32 v47, v48
    v_add_f32 v47, v47, v48
    v_mov_b32 v48, v47
    s_nop 1
    v_permlane32_swap_b32 v47, v48
    v_add_f32 v47, v47, v48
    s_lshl_b32 s40, s3, 3
    v_mov_b32 v48, s40
    s_mov_b64 exec, 1
    ds_write_b64 v48, v[46:47] offset:4096
    s_mov_b64 exec, -1
    s_mov_b32 s35, 0
    s_getreg_b32 s40, hwreg(HW_REG_XCC_ID, 0, 3)
    s_lshr_b32 s40, 85, s40
    s_and_b32 vcc_lo, s40, 1
    s_mov_b32 vcc_hi, 0
L_vloop:
    v_and_b32_dpp v34, v10, v6 row_newbcast:0 row_mask:0xf bank_mask:0xf
    v_and_b32_dpp v35, v10, v7 row_newbcast:0 row_mask:0xf bank_mask:0xf
    v_and_b32_dpp v36, v10, v8 row_newbcast:0 row_mask:0xf bank_mask:0xf
    v_and_b32_dpp v37, v10, v9 row_newbcast:0 row_mask:0xf bank_mask:0xf
    v_and_b32_dpp v38, v10, v6 row_newbcast:1 row_mask:0xf bank_mask:0xf
    v_and_b32_dpp v39, v10, v7 row_newbcast:1 row_mask:0xf bank_mask:0xf
    v_and_b32_dpp v40, v10, v8 row_newbcast:1 row_mask:0xf bank_mask:0xf
    v_and_b32_dpp v41, v10, v9 row_newbcast:1 row_mask:0xf bank_mask:0xf
    s_waitcnt vmcnt(15)
    s_cbranch_vccz L_dw33
    s_waitcnt vmcnt(6)
L_dw33:
    v_mfma_f32_16x16x32_bf16 v[42:45], v[34:37], v[64:67], v[42:45]
    buffer_load_dwordx4 v[64:67], v1, s[28:31], s34 offen nt
    s_add_u32 s34, s34, 4096
    v_and_b32_dpp v34, v10, v6 row_newbcast:2 row_mask:0xf bank_mask:0xf
    v_and_b32_dpp v35, v10, v7 row_newbcast:2 row_mask:0xf bank_mask:0xf
    v_and_b32_dpp v36, v10, v8 row_newbcast:2 row_mask:0xf bank_mask:0xf
    v_and_b32_dpp v37, v10, v9 row_newbcast:2 row_mask:0xf bank_mask:0xf
    s_waitcnt vmcnt(15)
    s_cbranch_vccz L_dw34
    s_waitcnt vmcnt(6)
L_dw34:
    v_mfma_f32_16x16x32_bf16 v[42:45], v[38:41], v[68:71], v[42:45]
    buffer_load_dwordx4 v[68:71], v1, s[28:31], s34 offen nt
    s_add_u32 s34, s34, 4096
    v_and_b32_dpp v38, v10, v6 row_newbcast:3 row_mask:0xf bank_mask:0xf
    v_and_b32_dpp v39, v10, v7 row_newbcast:3 row_mask:0xf bank_mask:0xf
    v_and_b32_dpp v40, v10, v8 row_newbcast:3 row_mask:0xf bank_mask:0xf
    v_and_b32_dpp v41, v10, v9 row_newbcast:3 row_mask:0xf bank_mask:0xf
    s_waitcnt vmcnt(15)
    s_cbranch_vccz L_dw35
    s_waitcnt vmcnt(5)
L_dw35:
    v_mfma_f32_16x16x32_bf16 v[42:45], v[34:37], v[72:75], v[42:45]
    buffer_load_dwordx4 v[72:75], v1, s[28:31], s34 offen nt
    s_add_u32 s34, s34, 4096
    v_and_b32_dpp v34, v10, v6 row_newbcast:4 row_mask:0xf bank_mask:0xf
    v_and_b32_dpp v35, v10, v7 row_newbcast:4 row_mask:0xf bank_mask:0xf
    v_and_b32_dpp v36, v10, v8 row_newbcast:4 row_mask:0xf bank_mask:0xf
    v_and_b32_dpp v37, v10, v9 row_newbcast:4 row_mask:0xf bank_mask:0xf
    s_waitcnt vmcnt(15)
    s_cbranch_vccz L_dw36
    s_waitcnt vmcnt(6)
L_dw36:
    v_mfma_f32_16x16x32_bf16 v[42:45], v[38:41], v[76:79], v[42:45]
    buffer_load_dwordx4 v[76:79], v1, s[28:31], s34 offen nt
    s_add_u32 s34, s34, 4096
    v_and_b32_dpp v38, v10, v6 row_newbcast:5 row_mask:0xf bank_mask:0xf
    v_and_b32_dpp v39, v10, v7 row_newbcast:5 row_mask:0xf bank_mask:0xf
    v_and_b32_dpp v40, v10, v8 row_newbcast:5 row_mask:0xf bank_mask:0xf
    v_and_b32_dpp v41, v10, v9 row_newbcast:5 row_mask:0xf bank_mask:0xf
    s_waitcnt vmcnt(15)
    s_cbranch_vccz L_dw37
    s_waitcnt vmcnt(6)
L_dw37:
    v_mfma_f32_16x16x32_bf16 v[42:45], v[34:37], v[80:83], v[42:45]
    buffer_load_dwordx4 v[80:83], v1, s[28:31], s34 offen nt
    s_add_u32 s34, s34, 4096
    v_and_b32_dpp v34, v10, v6 row_newbcast:6 row_mask:0xf bank_mask:0xf
    v_and_b32_dpp v35, v10, v7 row_newbcast:6 row_mask:0xf bank_mask:0xf
    v_and_b32_dpp v36, v10, v8 row_newbcast:6 row_mask:0xf bank_mask:0xf
    v_and_b32_dpp v37, v10, v9 row_newbcast:6 row_mask:0xf bank_mask:0xf
    s_waitcnt vmcnt(15)
    s_cbranch_vccz L_dw38
    s_waitcnt vmcnt(6)
L_dw38:
    v_mfma_f32_16x16x32_bf16 v[42:45], v[38:41], v[84:87], v[42:45]
    buffer_load_dwordx4 v[84:87], v1, s[28:31], s34 offen nt
    s_add_u32 s34, s34, 4096
    v_and_b32_dpp v38, v10, v6 row_newbcast:7 row_mask:0xf bank_mask:0xf
    v_and_b32_dpp v39, v10, v7 row_newbcast:7 row_mask:0xf bank_mask:0xf
    v_and_b32_dpp v40, v10, v8 row_newbcast:7 row_mask:0xf bank_mask:0xf
    v_and_b32_dpp v41, v10, v9 row_newbcast:7 row_mask:0xf bank_mask:0xf
    s_waitcnt vmcnt(15)
    s_cbranch_vccz L_dw39
    s_waitcnt vmcnt(5)
L_dw39:
    v_mfma_f32_16x16x32_bf16 v[42:45], v[34:37], v[88:91], v[42:45]
    buffer_load_dwordx4 v[88:91], v1, s[28:31], s34 offen nt
    s_add_u32 s34, s34, 4096
    v_and_b32_dpp v34, v10, v6 row_newbcast:8 row_mask:0xf bank_mask:0xf
    v_and_b32_dpp v35, v10, v7 row_newbcast:8 row_mask:0xf bank_mask:0xf
    v_and_b32_dpp v36, v10, v8 row_newbcast:8 row_mask:0xf bank_mask:0xf
    v_and_b32_dpp v37, v10, v9 row_newbcast:8 row_mask:0xf bank_mask:0xf
    s_waitcnt vmcnt(15)
    s_cbranch_vccz L_dw40
    s_waitcnt vmcnt(6)
L_dw40:
    v_mfma_f32_16x16x32_bf16 v[42:45], v[38:41], v[92:95], v[42:45]
    buffer_load_dwordx4 v[92:95], v1, s[28:31], s34 offen nt
    s_add_u32 s34, s34, 4096
    v_and_b32_dpp v38, v10, v6 row_newbcast:9 row_mask:0xf bank_mask:0xf
    v_and_b32_dpp v39, v10, v7 row_newbcast:9 row_mask:0xf bank_mask:0xf
    v_and_b32_dpp v40, v10, v8 row_newbcast:9 row_mask:0xf bank_mask:0xf
    v_and_b32_dpp v41, v10, v9 row_newbcast:9 row_mask:0xf bank_mask:0xf
    s_waitcnt vmcnt(15)
    s_cbranch_vccz L_dw41
    s_waitcnt vmcnt(6)
L_dw41:
    v_mfma_f32_16x16x32_bf16 v[42:45], v[34:37], v[96:99], v[42:45]
    buffer_load_dwordx4 v[96:99], v1, s[28:31], s34 offen nt
    s_add_u32 s34, s34, 4096
    v_and_b32_dpp v34, v10, v6 row_newbcast:10 row_mask:0xf bank_mask:0xf
    v_and_b32_dpp v35, v10, v7 row_newbcast:10 row_mask:0xf bank_mask:0xf
    v_and_b32_dpp v36, v10, v8 row_newbcast:10 row_mask:0xf bank_mask:0xf
    v_and_b32_dpp v37, v10, v9 row_newbcast:10 row_mask:0xf bank_mask:0xf
    s_waitcnt vmcnt(15)
    s_cbranch_vccz L_dw42
    s_waitcnt vmcnt(6)
L_dw42:
    v_mfma_f32_16x16x32_bf16 v[42:45], v[38:41], v[100:103], v[42:45]
    buffer_load_dwordx4 v[100:103], v1, s[28:31], s34 offen nt
    s_add_u32 s34, s34, 4096
    v_and_b32_dpp v38, v10, v6 row_newbcast:11 row_mask:0xf bank_mask:0xf
    v_and_b32_dpp v39, v10, v7 row_newbcast:11 row_mask:0xf bank_mask:0xf
    v_and_b32_dpp v40, v10, v8 row_newbcast:11 row_mask:0xf bank_mask:0xf
    v_and_b32_dpp v41, v10, v9 row_newbcast:11 row_mask:0xf bank_mask:0xf
    s_waitcnt vmcnt(15)
    s_cbranch_vccz L_dw43
    s_waitcnt vmcnt(5)
L_dw43:
    v_mfma_f32_16x16x32_bf16 v[42:45], v[34:37], v[104:107], v[42:45]
    buffer_load_dwordx4 v[104:107], v1, s[28:31], s34 offen nt
    s_add_u32 s34, s34, 4096
    v_and_b32_dpp v34, v10, v6 row_newbcast:12 row_mask:0xf bank_mask:0xf
    v_and_b32_dpp v35, v10, v7 row_newbcast:12 row_mask:0xf bank_mask:0xf
    v_and_b32_dpp v36, v10, v8 row_newbcast:12 row_mask:0xf bank_mask:0xf
    v_and_b32_dpp v37, v10, v9 row_newbcast:12 row_mask:0xf bank_mask:0xf
    s_waitcnt vmcnt(15)
    s_cbranch_vccz L_dw44
    s_waitcnt vmcnt(6)
L_dw44:
    v_mfma_f32_16x16x32_bf16 v[42:45], v[38:41], v[108:111], v[42:45]
    buffer_load_dwordx4 v[108:111], v1, s[28:31], s34 offen nt
    s_add_u32 s34, s34, 4096
    v_and_b32_dpp v38, v10, v6 row_newbcast:13 row_mask:0xf bank_mask:0xf
    v_and_b32_dpp v39, v10, v7 row_newbcast:13 row_mask:0xf bank_mask:0xf
    v_and_b32_dpp v40, v10, v8 row_newbcast:13 row_mask:0xf bank_mask:0xf
    v_and_b32_dpp v41, v10, v9 row_newbcast:13 row_mask:0xf bank_mask:0xf
    s_waitcnt vmcnt(15)
    s_cbranch_vccz L_dw45
    s_waitcnt vmcnt(6)
L_dw45:
    v_mfma_f32_16x16x32_bf16 v[42:45], v[34:37], v[112:115], v[42:45]
    buffer_load_dwordx4 v[112:115], v1, s[28:31], s34 offen nt
    s_add_u32 s34, s34, 4096
    v_and_b32_dpp v34, v10, v6 row_newbcast:14 row_mask:0xf bank_mask:0xf
    v_and_b32_dpp v35, v10, v7 row_newbcast:14 row_mask:0xf bank_mask:0xf
    v_and_b32_dpp v36, v10, v8 row_newbcast:14 row_mask:0xf bank_mask:0xf
    v_and_b32_dpp v37, v10, v9 row_newbcast:14 row_mask:0xf bank_mask:0xf
    s_waitcnt vmcnt(15)
    s_cbranch_vccz L_dw46
    s_waitcnt vmcnt(6)
L_dw46:
    v_mfma_f32_16x16x32_bf16 v[42:45], v[38:41], v[116:119], v[42:45]
    buffer_load_dwordx4 v[116:119], v1, s[28:31], s34 offen nt
    s_add_u32 s34, s34, 4096
    v_and_b32_dpp v38, v10, v6 row_newbcast:15 row_mask:0xf bank_mask:0xf
    v_and_b32_dpp v39, v10, v7 row_newbcast:15 row_mask:0xf bank_mask:0xf
    v_and_b32_dpp v40, v10, v8 row_newbcast:15 row_mask:0xf bank_mask:0xf
    v_and_b32_dpp v41, v10, v9 row_newbcast:15 row_mask:0xf bank_mask:0xf
    s_waitcnt vmcnt(15)
    s_cbranch_vccz L_dw47
    s_waitcnt vmcnt(5)
L_dw47:
    v_mfma_f32_16x16x32_bf16 v[42:45], v[34:37], v[120:123], v[42:45]
    buffer_load_dwordx4 v[120:123], v1, s[28:31], s34 offen nt
    s_add_u32 s34, s34, 4096
    s_waitcnt vmcnt(15)
    s_cbranch_vccz L_dw48
    s_waitcnt vmcnt(6)
L_dw48:
    v_mfma_f32_16x16x32_bf16 v[42:45], v[38:41], v[124:127], v[42:45]
    buffer_load_dwordx4 v[124:127], v1, s[28:31], s34 offen nt
    s_add_u32 s34, s34, 4096
    v_and_b32_dpp v34, v11, v6 row_newbcast:0 row_mask:0xf bank_mask:0xf
    v_and_b32_dpp v35, v11, v7 row_newbcast:0 row_mask:0xf bank_mask:0xf
    v_and_b32_dpp v36, v11, v8 row_newbcast:0 row_mask:0xf bank_mask:0xf
    v_and_b32_dpp v37, v11, v9 row_newbcast:0 row_mask:0xf bank_mask:0xf
    v_and_b32_dpp v38, v11, v6 row_newbcast:1 row_mask:0xf bank_mask:0xf
    v_and_b32_dpp v39, v11, v7 row_newbcast:1 row_mask:0xf bank_mask:0xf
    v_and_b32_dpp v40, v11, v8 row_newbcast:1 row_mask:0xf bank_mask:0xf
    v_and_b32_dpp v41, v11, v9 row_newbcast:1 row_mask:0xf bank_mask:0xf
    s_waitcnt vmcnt(15)
    s_cbranch_vccz L_dw49
    s_waitcnt vmcnt(6)
L_dw49:
    v_mfma_f32_16x16x32_bf16 v[42:45], v[34:37], v[128:131], v[42:45]
    buffer_load_dwordx4 v[128:131], v1, s[28:31], s34 offen nt
    s_add_u32 s34, s34, 4096
    v_and_b32_dpp v34, v11, v6 row_newbcast:2 row_mask:0xf bank_mask:0xf
    v_and_b32_dpp v35, v11, v7 row_newbcast:2 row_mask:0xf bank_mask:0xf
    v_and_b32_dpp v36, v11, v8 row_newbcast:2 row_mask:0xf bank_mask:0xf
    v_and_b32_dpp v37, v11, v9 row_newbcast:2 row_mask:0xf bank_mask:0xf
    s_waitcnt vmcnt(15)
    s_cbranch_vccz L_dw50
    s_waitcnt vmcnt(6)
L_dw50:
    v_mfma_f32_16x16x32_bf16 v[42:45], v[38:41], v[132:135], v[42:45]
    buffer_load_dwordx4 v[132:135], v1, s[28:31], s34 offen nt
    s_add_u32 s34, s34, 4096
    v_and_b32_dpp v38, v11, v6 row_newbcast:3 row_mask:0xf bank_mask:0xf
    v_and_b32_dpp v39, v11, v7 row_newbcast:3 row_mask:0xf bank_mask:0xf
    v_and_b32_dpp v40, v11, v8 row_newbcast:3 row_mask:0xf bank_mask:0xf
    v_and_b32_dpp v41, v11, v9 row_newbcast:3 row_mask:0xf bank_mask:0xf
    s_waitcnt vmcnt(15)
    s_cbranch_vccz L_dw51
    s_waitcnt vmcnt(5)
L_dw51:
    v_mfma_f32_16x16x32_bf16 v[42:45], v[34:37], v[136:139], v[42:45]
    buffer_load_dwordx4 v[136:139], v1, s[28:31], s34 offen nt
    s_add_u32 s34, s34, 4096
    v_and_b32_dpp v34, v11, v6 row_newbcast:4 row_mask:0xf bank_mask:0xf
    v_and_b32_dpp v35, v11, v7 row_newbcast:4 row_mask:0xf bank_mask:0xf
    v_and_b32_dpp v36, v11, v8 row_newbcast:4 row_mask:0xf bank_mask:0xf
    v_and_b32_dpp v37, v11, v9 row_newbcast:4 row_mask:0xf bank_mask:0xf
    s_waitcnt vmcnt(15)
    s_cbranch_vccz L_dw52
    s_waitcnt vmcnt(6)
L_dw52:
    v_mfma_f32_16x16x32_bf16 v[42:45], v[38:41], v[140:143], v[42:45]
    buffer_load_dwordx4 v[140:143], v1, s[28:31], s34 offen nt
    s_add_u32 s34, s34, 4096
    v_and_b32_dpp v38, v11, v6 row_newbcast:5 row_mask:0xf bank_mask:0xf
    v_and_b32_dpp v39, v11, v7 row_newbcast:5 row_mask:0xf bank_mask:0xf
    v_and_b32_dpp v40, v11, v8 row_newbcast:5 row_mask:0xf bank_mask:0xf
    v_and_b32_dpp v41, v11, v9 row_newbcast:5 row_mask:0xf bank_mask:0xf
    s_waitcnt vmcnt(15)
    s_cbranch_vccz L_dw53
    s_waitcnt vmcnt(6)
L_dw53:
    v_mfma_f32_16x16x32_bf16 v[42:45], v[34:37], v[144:147], v[42:45]
    buffer_load_dwordx4 v[144:147], v1, s[28:31], s34 offen nt
    s_add_u32 s34, s34, 4096
    v_and_b32_dpp v34, v11, v6 row_newbcast:6 row_mask:0xf bank_mask:0xf
    v_and_b32_dpp v35, v11, v7 row_newbcast:6 row_mask:0xf bank_mask:0xf
    v_and_b32_dpp v36, v11, v8 row_newbcast:6 row_mask:0xf bank_mask:0xf
    v_and_b32_dpp v37, v11, v9 row_newbcast:6 row_mask:0xf bank_mask:0xf
    s_waitcnt vmcnt(15)
    s_cbranch_vccz L_dw54
    s_waitcnt vmcnt(6)
L_dw54:
    v_mfma_f32_16x16x32_bf16 v[42:45], v[38:41], v[148:151], v[42:45]
    buffer_load_dwordx4 v[148:151], v1, s[28:31], s34 offen nt
    s_add_u32 s34, s34, 4096
    v_and_b32_dpp v38, v11, v6 row_newbcast:7 row_mask:0xf bank_mask:0xf
    v_and_b32_dpp v39, v11, v7 row_newbcast:7 row_mask:0xf bank_mask:0xf
    v_and_b32_dpp v40, v11, v8 row_newbcast:7 row_mask:0xf bank_mask:0xf
    v_and_b32_dpp v41, v11, v9 row_newbcast:7 row_mask:0xf bank_mask:0xf
    s_waitcnt vmcnt(15)
    s_cbranch_vccz L_dw55
    s_waitcnt vmcnt(5)
L_dw55:
    v_mfma_f32_16x16x32_bf16 v[42:45], v[34:37], v[152:155], v[42:45]
    buffer_load_dwordx4 v[152:155], v1, s[28:31], s34 offen nt
    s_add_u32 s34, s34, 4096
    v_and_b32_dpp v34, v11, v6 row_newbcast:8 row_mask:0xf bank_mask:0xf
    v_and_b32_dpp v35, v11, v7 row_newbcast:8 row_mask:0xf bank_mask:0xf
    v_and_b32_dpp v36, v11, v8 row_newbcast:8 row_mask:0xf bank_mask:0xf
    v_and_b32_dpp v37, v11, v9 row_newbcast:8 row_mask:0xf bank_mask:0xf
    s_waitcnt vmcnt(15)
    s_cbranch_vccz L_dw56
    s_waitcnt vmcnt(6)
L_dw56:
    v_mfma_f32_16x16x32_bf16 v[42:45], v[38:41], v[156:159], v[42:45]
    buffer_load_dwordx4 v[156:159], v1, s[28:31], s34 offen nt
    s_add_u32 s34, s34, 4096
    v_and_b32_dpp v38, v11, v6 row_newbcast:9 row_mask:0xf bank_mask:0xf
    v_and_b32_dpp v39, v11, v7 row_newbcast:9 row_mask:0xf bank_mask:0xf
    v_and_b32_dpp v40, v11, v8 row_newbcast:9 row_mask:0xf bank_mask:0xf
    v_and_b32_dpp v41, v11, v9 row_newbcast:9 row_mask:0xf bank_mask:0xf
    s_waitcnt vmcnt(15)
    s_cbranch_vccz L_dw57
    s_waitcnt vmcnt(6)
L_dw57:
    v_mfma_f32_16x16x32_bf16 v[42:45], v[34:37], v[160:163], v[42:45]
    buffer_load_dwordx4 v[160:163], v1, s[28:31], s34 offen nt
    s_add_u32 s34, s34, 4096
    v_and_b32_dpp v34, v11, v6 row_newbcast:10 row_mask:0xf bank_mask:0xf
    v_and_b32_dpp v35, v11, v7 row_newbcast:10 row_mask:0xf bank_mask:0xf
    v_and_b32_dpp v36, v11, v8 row_newbcast:10 row_mask:0xf bank_mask:0xf
    v_and_b32_dpp v37, v11, v9 row_newbcast:10 row_mask:0xf bank_mask:0xf
    s_waitcnt vmcnt(15)
    s_cbranch_vccz L_dw58
    s_waitcnt vmcnt(6)
L_dw58:
    v_mfma_f32_16x16x32_bf16 v[42:45], v[38:41], v[164:167], v[42:45]
    buffer_load_dwordx4 v[164:167], v1, s[28:31], s34 offen nt
    s_add_u32 s34, s34, 4096
    v_and_b32_dpp v38, v11, v6 row_newbcast:11 row_mask:0xf bank_mask:0xf
    v_and_b32_dpp v39, v11, v7 row_newbcast:11 row_mask:0xf bank_mask:0xf
    v_and_b32_dpp v40, v11, v8 row_newbcast:11 row_mask:0xf bank_mask:0xf
    v_and_b32_dpp v41, v11, v9 row_newbcast:11 row_mask:0xf bank_mask:0xf
    s_waitcnt vmcnt(15)
    s_cbranch_vccz L_dw59
    s_waitcnt vmcnt(5)
L_dw59:
    v_mfma_f32_16x16x32_bf16 v[42:45], v[34:37], v[168:171], v[42:45]
    buffer_load_dwordx4 v[168:171], v1, s[28:31], s34 offen nt
    s_add_u32 s34, s34, 4096
    v_and_b32_dpp v34, v11, v6 row_newbcast:12 row_mask:0xf bank_mask:0xf
    v_and_b32_dpp v35, v11, v7 row_newbcast:12 row_mask:0xf bank_mask:0xf
    v_and_b32_dpp v36, v11, v8 row_newbcast:12 row_mask:0xf bank_mask:0xf
    v_and_b32_dpp v37, v11, v9 row_newbcast:12 row_mask:0xf bank_mask:0xf
    s_waitcnt vmcnt(15)
    s_cbranch_vccz L_dw60
    s_waitcnt vmcnt(6)
L_dw60:
    v_mfma_f32_16x16x32_bf16 v[42:45], v[38:41], v[172:175], v[42:45]
    buffer_load_dwordx4 v[172:175], v1, s[28:31], s34 offen nt
    s_add_u32 s34, s34, 4096
    v_and_b32_dpp v38, v11, v6 row_newbcast:13 row_mask:0xf bank_mask:0xf
    v_and_b32_dpp v39, v11, v7 row_newbcast:13 row_mask:0xf bank_mask:0xf
    v_and_b32_dpp v40, v11, v8 row_newbcast:13 row_mask:0xf bank_mask:0xf
    v_and_b32_dpp v41, v11, v9 row_newbcast:13 row_mask:0xf bank_mask:0xf
    s_waitcnt vmcnt(15)
    s_cbranch_vccz L_dw61
    s_waitcnt vmcnt(6)
L_dw61:
    v_mfma_f32_16x16x32_bf16 v[42:45], v[34:37], v[176:179], v[42:45]
    buffer_load_dwordx4 v[176:179], v1, s[28:31], s34 offen nt
    s_add_u32 s34, s34, 4096
    v_and_b32_dpp v34, v11, v6 row_newbcast:14 row_mask:0xf bank_mask:0xf
    v_and_b32_dpp v35, v11, v7 row_newbcast:14 row_mask:0xf bank_mask:0xf
    v_and_b32_dpp v36, v11, v8 row_newbcast:14 row_mask:0xf bank_mask:0xf
    v_and_b32_dpp v37, v11, v9 row_newbcast:14 row_mask:0xf bank_mask:0xf
    s_waitcnt vmcnt(15)
    s_cbranch_vccz L_dw62
    s_waitcnt vmcnt(6)
L_dw62:
    v_mfma_f32_16x16x32_bf16 v[42:45], v[38:41], v[180:183], v[42:45]
    buffer_load_dwordx4 v[180:183], v1, s[28:31], s34 offen nt
    s_add_u32 s34, s34, 4096
    v_and_b32_dpp v38, v11, v6 row_newbcast:15 row_mask:0xf bank_mask:0xf
    v_and_b32_dpp v39, v11, v7 row_newbcast:15 row_mask:0xf bank_mask:0xf
    v_and_b32_dpp v40, v11, v8 row_newbcast:15 row_mask:0xf bank_mask:0xf
    v_and_b32_dpp v41, v11, v9 row_newbcast:15 row_mask:0xf bank_mask:0xf
    s_waitcnt vmcnt(15)
    s_cbranch_vccz L_dw63
    s_waitcnt vmcnt(5)
L_dw63:
    v_mfma_f32_16x16x32_bf16 v[42:45], v[34:37], v[184:187], v[42:45]
    buffer_load_dwordx4 v[184:187], v1, s[28:31], s34 offen nt
    s_add_u32 s34, s34, 4096
    s_waitcnt vmcnt(15)
    s_cbranch_vccz L_dw64
    s_waitcnt vmcnt(6)
L_dw64:
    v_mfma_f32_16x16x32_bf16 v[42:45], v[38:41], v[188:191], v[42:45]
    buffer_load_dwordx4 v[188:191], v1, s[28:31], s34 offen nt
    s_add_u32 s34, s34, 4096
    s_and_b32 s34, s34, 0x7ffff
    v_mov_b32 v10, v12
    v_mov_b32 v11, v13
    v_mov_b32 v12, v14
    v_mov_b32 v13, v15
    v_mov_b32 v14, v16
    v_mov_b32 v15, v17
    s_add_u32 s35, s35, 1
    s_cmp_lt_u32 s35, 3
    s_nop 1
    s_cbranch_scc1 L_vloop
    s_barrier
    s_setprio 3
    v_mov_b32 v19, 0
    v_mov_b32 v20, 1
    ds_read_b128 v[26:29], v19 offset:7424
    ds_read_b32 v23, v19 offset:7440
    v_lshlrev_b32 v21, 3, v0
    v_lshrrev_b32 v22, 2, v0
    v_lshlrev_b32 v22, 4, v22
    s_mov_b32 s44, s24
    s_mov_b32 s45, s25
    s_mov_b32 s46, 503808
    s_mov_b32 s47, 0x20000
    s_lshl_b32 s53, s26, 3
    s_add_u32 s53, s53, s27
    s_lshl_b32 s53, s53, 8
    s_add_u32 s53, s53, 20480
    s_waitcnt lgkmcnt(0)
    v_readfirstlane_b32 s52, v23
    v_and_b32_dpp v34, v10, v6 row_newbcast:0 row_mask:0xf bank_mask:0xf
    v_and_b32_dpp v35, v10, v7 row_newbcast:0 row_mask:0xf bank_mask:0xf
    v_and_b32_dpp v36, v10, v8 row_newbcast:0 row_mask:0xf bank_mask:0xf
    v_and_b32_dpp v37, v10, v9 row_newbcast:0 row_mask:0xf bank_mask:0xf
    v_and_b32_dpp v38, v10, v6 row_newbcast:1 row_mask:0xf bank_mask:0xf
    v_and_b32_dpp v39, v10, v7 row_newbcast:1 row_mask:0xf bank_mask:0xf
    v_and_b32_dpp v40, v10, v8 row_newbcast:1 row_mask:0xf bank_mask:0xf
    v_and_b32_dpp v41, v10, v9 row_newbcast:1 row_mask:0xf bank_mask:0xf
    s_waitcnt vmcnt(31)
    v_mfma_f32_16x16x32_bf16 v[42:45], v[34:37], v[64:67], v[42:45]
    v_and_b32_dpp v34, v10, v6 row_newbcast:2 row_mask:0xf bank_mask:0xf
    v_and_b32_dpp v35, v10, v7 row_newbcast:2 row_mask:0xf bank_mask:0xf
    v_and_b32_dpp v36, v10, v8 row_newbcast:2 row_mask:0xf bank_mask:0xf
    v_and_b32_dpp v37, v10, v9 row_newbcast:2 row_mask:0xf bank_mask:0xf
    s_waitcnt vmcnt(30)
    v_mfma_f32_16x16x32_bf16 v[42:45], v[38:41], v[68:71], v[42:45]
    v_and_b32_dpp v38, v10, v6 row_newbcast:3 row_mask:0xf bank_mask:0xf
    v_and_b32_dpp v39, v10, v7 row_newbcast:3 row_mask:0xf bank_mask:0xf
    v_and_b32_dpp v40, v10, v8 row_newbcast:3 row_mask:0xf bank_mask:0xf
    v_and_b32_dpp v41, v10, v9 row_newbcast:3 row_mask:0xf bank_mask:0xf
    s_waitcnt vmcnt(29)
    v_mfma_f32_16x16x32_bf16 v[42:45], v[34:37], v[72:75], v[42:45]
    v_and_b32_dpp v34, v10, v6 row_newbcast:4 row_mask:0xf bank_mask:0xf
    v_and_b32_dpp v35, v10, v7 row_newbcast:4 row_mask:0xf bank_mask:0xf
    v_and_b32_dpp v36, v10, v8 row_newbcast:4 row_mask:0xf bank_mask:0xf
    v_and_b32_dpp v37, v10, v9 row_newbcast:4 row_mask:0xf bank_mask:0xf
    s_waitcnt vmcnt(28)
    v_mfma_f32_16x16x32_bf16 v[42:45], v[38:41], v[76:79], v[42:45]
    v_and_b32_dpp v38, v10, v6 row_newbcast:5 row_mask:0xf bank_mask:0xf
    v_and_b32_dpp v39, v10, v7 row_newbcast:5 row_mask:0xf bank_mask:0xf
    v_and_b32_dpp v40, v10, v8 row_newbcast:5 row_mask:0xf bank_mask:0xf
    v_and_b32_dpp v41, v10, v9 row_newbcast:5 row_mask:0xf bank_mask:0xf
    s_waitcnt vmcnt(27)
    v_mfma_f32_16x16x32_bf16 v[42:45], v[34:37], v[80:83], v[42:45]
    v_and_b32_dpp v34, v10, v6 row_newbcast:6 row_mask:0xf bank_mask:0xf
    v_and_b32_dpp v35, v10, v7 row_newbcast:6 row_mask:0xf bank_mask:0xf
    v_and_b32_dpp v36, v10, v8 row_newbcast:6 row_mask:0xf bank_mask:0xf
    v_and_b32_dpp v37, v10, v9 row_newbcast:6 row_mask:0xf bank_mask:0xf
    s_waitcnt vmcnt(26)
    v_mfma_f32_16x16x32_bf16 v[42:45], v[38:41], v[84:87], v[42:45]
    v_and_b32_dpp v38, v10, v6 row_newbcast:7 row_mask:0xf bank_mask:0xf
    v_and_b32_dpp v39, v10, v7 row_newbcast:7 row_mask:0xf bank_mask:0xf
    v_and_b32_dpp v40, v10, v8 row_newbcast:7 row_mask:0xf bank_mask:0xf
    v_and_b32_dpp v41, v10, v9 row_newbcast:7 row_mask:0xf bank_mask:0xf
    s_waitcnt vmcnt(25)
    v_mfma_f32_16x16x32_bf16 v[42:45], v[34:37], v[88:91], v[42:45]
    v_and_b32_dpp v34, v10, v6 row_newbcast:8 row_mask:0xf bank_mask:0xf
    v_and_b32_dpp v35, v10, v7 row_newbcast:8 row_mask:0xf bank_mask:0xf
    v_and_b32_dpp v36, v10, v8 row_newbcast:8 row_mask:0xf bank_mask:0xf
    v_and_b32_dpp v37, v10, v9 row_newbcast:8 row_mask:0xf bank_mask:0xf
    s_waitcnt vmcnt(24)
    v_mfma_f32_16x16x32_bf16 v[42:45], v[38:41], v[92:95], v[42:45]
    v_and_b32_dpp v38, v10, v6 row_newbcast:9 row_mask:0xf bank_mask:0xf
    v_and_b32_dpp v39, v10, v7 row_newbcast:9 row_mask:0xf bank_mask:0xf
    v_and_b32_dpp v40, v10, v8 row_newbcast:9 row_mask:0xf bank_mask:0xf
    v_and_b32_dpp v41, v10, v9 row_newbcast:9 row_mask:0xf bank_mask:0xf
    s_waitcnt vmcnt(23)
    v_mfma_f32_16x16x32_bf16 v[42:45], v[34:37], v[96:99], v[42:45]
    v_and_b32_dpp v34, v10, v6 row_newbcast:10 row_mask:0xf bank_mask:0xf
    v_and_b32_dpp v35, v10, v7 row_newbcast:10 row_mask:0xf bank_mask:0xf
    v_and_b32_dpp v36, v10, v8 row_newbcast:10 row_mask:0xf bank_mask:0xf
    v_and_b32_dpp v37, v10, v9 row_newbcast:10 row_mask:0xf bank_mask:0xf
    s_waitcnt vmcnt(22)
    v_mfma_f32_16x16x32_bf16 v[42:45], v[38:41], v[100:103], v[42:45]
    v_and_b32_dpp v38, v10, v6 row_newbcast:11 row_mask:0xf bank_mask:0xf
    v_and_b32_dpp v39, v10, v7 row_newbcast:11 row_mask:0xf bank_mask:0xf
    v_and_b32_dpp v40, v10, v8 row_newbcast:11 row_mask:0xf bank_mask:0xf
    v_and_b32_dpp v41, v10, v9 row_newbcast:11 row_mask:0xf bank_mask:0xf
    s_waitcnt vmcnt(21)
    v_mfma_f32_16x16x32_bf16 v[42:45], v[34:37], v[104:107], v[42:45]
    v_and_b32_dpp v34, v10, v6 row_newbcast:12 row_mask:0xf bank_mask:0xf
    v_and_b32_dpp v35, v10, v7 row_newbcast:12 row_mask:0xf bank_mask:0xf
    v_and_b32_dpp v36, v10, v8 row_newbcast:12 row_mask:0xf bank_mask:0xf
    v_and_b32_dpp v37, v10, v9 row_newbcast:12 row_mask:0xf bank_mask:0xf
    s_waitcnt vmcnt(20)
    v_mfma_f32_16x16x32_bf16 v[42:45], v[38:41], v[108:111], v[42:45]
    v_and_b32_dpp v38, v10, v6 row_newbcast:13 row_mask:0xf bank_mask:0xf
    v_and_b32_dpp v39, v10, v7 row_newbcast:13 row_mask:0xf bank_mask:0xf
    v_and_b32_dpp v40, v10, v8 row_newbcast:13 row_mask:0xf bank_mask:0xf
    v_and_b32_dpp v41, v10, v9 row_newbcast:13 row_mask:0xf bank_mask:0xf
    s_waitcnt vmcnt(19)
    v_mfma_f32_16x16x32_bf16 v[42:45], v[34:37], v[112:115], v[42:45]
    v_and_b32_dpp v34, v10, v6 row_newbcast:14 row_mask:0xf bank_mask:0xf
    v_and_b32_dpp v35, v10, v7 row_newbcast:14 row_mask:0xf bank_mask:0xf
    v_and_b32_dpp v36, v10, v8 row_newbcast:14 row_mask:0xf bank_mask:0xf
    v_and_b32_dpp v37, v10, v9 row_newbcast:14 row_mask:0xf bank_mask:0xf
    s_waitcnt vmcnt(18)
    v_mfma_f32_16x16x32_bf16 v[42:45], v[38:41], v[116:119], v[42:45]
    v_and_b32_dpp v38, v10, v6 row_newbcast:15 row_mask:0xf bank_mask:0xf
    v_and_b32_dpp v39, v10, v7 row_newbcast:15 row_mask:0xf bank_mask:0xf
    v_and_b32_dpp v40, v10, v8 row_newbcast:15 row_mask:0xf bank_mask:0xf
    v_and_b32_dpp v41, v10, v9 row_newbcast:15 row_mask:0xf bank_mask:0xf
    s_waitcnt vmcnt(17)
    v_mfma_f32_16x16x32_bf16 v[42:45], v[34:37], v[120:123], v[42:45]
    s_waitcnt vmcnt(16)
    v_mfma_f32_16x16x32_bf16 v[42:45], v[38:41], v[124:127], v[42:45]
    v_and_b32_dpp v34, v11, v6 row_newbcast:0 row_mask:0xf bank_mask:0xf
    v_and_b32_dpp v35, v11, v7 row_newbcast:0 row_mask:0xf bank_mask:0xf
    v_and_b32_dpp v36, v11, v8 row_newbcast:0 row_mask:0xf bank_mask:0xf
    v_and_b32_dpp v37, v11, v9 row_newbcast:0 row_mask:0xf bank_mask:0xf
    v_and_b32_dpp v38, v11, v6 row_newbcast:1 row_mask:0xf bank_mask:0xf
    v_and_b32_dpp v39, v11, v7 row_newbcast:1 row_mask:0xf bank_mask:0xf
    v_and_b32_dpp v40, v11, v8 row_newbcast:1 row_mask:0xf bank_mask:0xf
    v_and_b32_dpp v41, v11, v9 row_newbcast:1 row_mask:0xf bank_mask:0xf
    s_waitcnt vmcnt(15)
    v_mfma_f32_16x16x32_bf16 v[42:45], v[34:37], v[128:131], v[42:45]
    v_and_b32_dpp v34, v11, v6 row_newbcast:2 row_mask:0xf bank_mask:0xf
    v_and_b32_dpp v35, v11, v7 row_newbcast:2 row_mask:0xf bank_mask:0xf
    v_and_b32_dpp v36, v11, v8 row_newbcast:2 row_mask:0xf bank_mask:0xf
    v_and_b32_dpp v37, v11, v9 row_newbcast:2 row_mask:0xf bank_mask:0xf
    s_waitcnt vmcnt(14)
    v_mfma_f32_16x16x32_bf16 v[42:45], v[38:41], v[132:135], v[42:45]
    v_and_b32_dpp v38, v11, v6 row_newbcast:3 row_mask:0xf bank_mask:0xf
    v_and_b32_dpp v39, v11, v7 row_newbcast:3 row_mask:0xf bank_mask:0xf
    v_and_b32_dpp v40, v11, v8 row_newbcast:3 row_mask:0xf bank_mask:0xf
    v_and_b32_dpp v41, v11, v9 row_newbcast:3 row_mask:0xf bank_mask:0xf
    s_waitcnt vmcnt(13)
    v_mfma_f32_16x16x32_bf16 v[42:45], v[34:37], v[136:139], v[42:45]
    v_and_b32_dpp v34, v11, v6 row_newbcast:4 row_mask:0xf bank_mask:0xf
    v_and_b32_dpp v35, v11, v7 row_newbcast:4 row_mask:0xf bank_mask:0xf
    v_and_b32_dpp v36, v11, v8 row_newbcast:4 row_mask:0xf bank_mask:0xf
    v_and_b32_dpp v37, v11, v9 row_newbcast:4 row_mask:0xf bank_mask:0xf
    s_waitcnt vmcnt(12)
    v_mfma_f32_16x16x32_bf16 v[42:45], v[38:41], v[140:143], v[42:45]
    v_and_b32_dpp v38, v11, v6 row_newbcast:5 row_mask:0xf bank_mask:0xf
    v_and_b32_dpp v39, v11, v7 row_newbcast:5 row_mask:0xf bank_mask:0xf
    v_and_b32_dpp v40, v11, v8 row_newbcast:5 row_mask:0xf bank_mask:0xf
    v_and_b32_dpp v41, v11, v9 row_newbcast:5 row_mask:0xf bank_mask:0xf
    s_waitcnt vmcnt(11)
    v_mfma_f32_16x16x32_bf16 v[42:45], v[34:37], v[144:147], v[42:45]
    v_and_b32_dpp v34, v11, v6 row_newbcast:6 row_mask:0xf bank_mask:0xf
    v_and_b32_dpp v35, v11, v7 row_newbcast:6 row_mask:0xf bank_mask:0xf
    v_and_b32_dpp v36, v11, v8 row_newbcast:6 row_mask:0xf bank_mask:0xf
    v_and_b32_dpp v37, v11, v9 row_newbcast:6 row_mask:0xf bank_mask:0xf
    s_waitcnt vmcnt(10)
    v_mfma_f32_16x16x32_bf16 v[42:45], v[38:41], v[148:151], v[42:45]
    v_and_b32_dpp v38, v11, v6 row_newbcast:7 row_mask:0xf bank_mask:0xf
    v_and_b32_dpp v39, v11, v7 row_newbcast:7 row_mask:0xf bank_mask:0xf
    v_and_b32_dpp v40, v11, v8 row_newbcast:7 row_mask:0xf bank_mask:0xf
    v_and_b32_dpp v41, v11, v9 row_newbcast:7 row_mask:0xf bank_mask:0xf
    s_waitcnt vmcnt(9)
    v_mfma_f32_16x16x32_bf16 v[42:45], v[34:37], v[152:155], v[42:45]
    v_and_b32_dpp v34, v11, v6 row_newbcast:8 row_mask:0xf bank_mask:0xf
    v_and_b32_dpp v35, v11, v7 row_newbcast:8 row_mask:0xf bank_mask:0xf
    v_and_b32_dpp v36, v11, v8 row_newbcast:8 row_mask:0xf bank_mask:0xf
    v_and_b32_dpp v37, v11, v9 row_newbcast:8 row_mask:0xf bank_mask:0xf
    s_waitcnt vmcnt(8)
    v_mfma_f32_16x16x32_bf16 v[42:45], v[38:41], v[156:159], v[42:45]
    v_and_b32_dpp v38, v11, v6 row_newbcast:9 row_mask:0xf bank_mask:0xf
    v_and_b32_dpp v39, v11, v7 row_newbcast:9 row_mask:0xf bank_mask:0xf
    v_and_b32_dpp v40, v11, v8 row_newbcast:9 row_mask:0xf bank_mask:0xf
    v_and_b32_dpp v41, v11, v9 row_newbcast:9 row_mask:0xf bank_mask:0xf
    s_waitcnt vmcnt(7)
    v_mfma_f32_16x16x32_bf16 v[42:45], v[34:37], v[160:163], v[42:45]
    v_and_b32_dpp v34, v11, v6 row_newbcast:10 row_mask:0xf bank_mask:0xf
    v_and_b32_dpp v35, v11, v7 row_newbcast:10 row_mask:0xf bank_mask:0xf
    v_and_b32_dpp v36, v11, v8 row_newbcast:10 row_mask:0xf bank_mask:0xf
    v_and_b32_dpp v37, v11, v9 row_newbcast:10 row_mask:0xf bank_mask:0xf
    s_waitcnt vmcnt(6)
    v_mfma_f32_16x16x32_bf16 v[42:45], v[38:41], v[164:167], v[42:45]
    v_and_b32_dpp v38, v11, v6 row_newbcast:11 row_mask:0xf bank_mask:0xf
    v_and_b32_dpp v39, v11, v7 row_newbcast:11 row_mask:0xf bank_mask:0xf
    v_and_b32_dpp v40, v11, v8 row_newbcast:11 row_mask:0xf bank_mask:0xf
    v_and_b32_dpp v41, v11, v9 row_newbcast:11 row_mask:0xf bank_mask:0xf
    s_waitcnt vmcnt(5)
    v_mfma_f32_16x16x32_bf16 v[42:45], v[34:37], v[168:171], v[42:45]
    v_and_b32_dpp v34, v11, v6 row_newbcast:12 row_mask:0xf bank_mask:0xf
    v_and_b32_dpp v35, v11, v7 row_newbcast:12 row_mask:0xf bank_mask:0xf
    v_and_b32_dpp v36, v11, v8 row_newbcast:12 row_mask:0xf bank_mask:0xf
    v_and_b32_dpp v37, v11, v9 row_newbcast:12 row_mask:0xf bank_mask:0xf
    s_waitcnt vmcnt(4)
    v_mfma_f32_16x16x32_bf16 v[42:45], v[38:41], v[172:175], v[42:45]
    v_and_b32_dpp v38, v11, v6 row_newbcast:13 row_mask:0xf bank_mask:0xf
    v_and_b32_dpp v39, v11, v7 row_newbcast:13 row_mask:0xf bank_mask:0xf
    v_and_b32_dpp v40, v11, v8 row_newbcast:13 row_mask:0xf bank_mask:0xf
    v_and_b32_dpp v41, v11, v9 row_newbcast:13 row_mask:0xf bank_mask:0xf
    s_waitcnt vmcnt(3)
    v_mfma_f32_16x16x32_bf16 v[42:45], v[34:37], v[176:179], v[42:45]
    v_and_b32_dpp v34, v11, v6 row_newbcast:14 row_mask:0xf bank_mask:0xf
    v_and_b32_dpp v35, v11, v7 row_newbcast:14 row_mask:0xf bank_mask:0xf
    v_and_b32_dpp v36, v11, v8 row_newbcast:14 row_mask:0xf bank_mask:0xf
    v_and_b32_dpp v37, v11, v9 row_newbcast:14 row_mask:0xf bank_mask:0xf
    s_waitcnt vmcnt(2)
    v_mfma_f32_16x16x32_bf16 v[42:45], v[38:41], v[180:183], v[42:45]
    v_and_b32_dpp v38, v11, v6 row_newbcast:15 row_mask:0xf bank_mask:0xf
    v_and_b32_dpp v39, v11, v7 row_newbcast:15 row_mask:0xf bank_mask:0xf
    v_and_b32_dpp v40, v11, v8 row_newbcast:15 row_mask:0xf bank_mask:0xf
    v_and_b32_dpp v41, v11, v9 row_newbcast:15 row_mask:0xf bank_mask:0xf
    s_waitcnt vmcnt(1)
    v_mfma_f32_16x16x32_bf16 v[42:45], v[34:37], v[184:187], v[42:45]
    s_waitcnt vmcnt(0)
    v_mfma_f32_16x16x32_bf16 v[42:45], v[38:41], v[188:191], v[42:45]
    s_mov_b32 exec_hi, 0
    s_nop 6
    ds_write_b128 v50, v[42:45] offset:2048
    s_mov_b64 exec, 1
    ds_add_rtn_u32 v18, v19, v20 offset:7456
    s_mov_b64 exec, -1
    ds_read_b64 v[64:65], v21 offset:2048
    ds_read_b64 v[66:67], v21 offset:2560
    ds_read_b64 v[68:69], v21 offset:3072
    ds_read_b64 v[70:71], v21 offset:3584
    s_waitcnt lgkmcnt(0)
    v_readfirstlane_b32 s40, v18
    s_nop 0
    s_cmp_eq_u32 s40, 3
    s_cbranch_scc0 L_sdone
    v_mul_f32 v34, v26, v64
    v_mul_f32 v35, v26, v65
    v_fmac_f32 v34, v27, v66
    v_fmac_f32 v35, v27, v67
    v_fmac_f32 v34, v28, v68
    v_fmac_f32 v35, v28, v69
    v_fmac_f32 v34, v29, v70
    v_fmac_f32 v35, v29, v71
    v_cvt_pk_bf16_f32 v38, v34, v35
    s_nop 1
    v_mov_b32_dpp v39, v38 quad_perm:[1,1,1,1] row_mask:0xf bank_mask:0xf
    v_mov_b32_dpp v40, v38 quad_perm:[2,2,2,2] row_mask:0xf bank_mask:0xf
    v_mov_b32_dpp v41, v38 quad_perm:[3,3,3,3] row_mask:0xf bank_mask:0xf
    s_mov_b32 exec_lo, 0x11111111
    s_mov_b32 exec_hi, 0x11111111
    s_cmp_eq_u32 s52, 0
    s_cbranch_scc0 L_sfar
    buffer_store_dwordx4 v[38:41], v22, s[44:47], s53 offen
    s_branch L_sdone
L_sfar:
    buffer_store_dwordx4 v[38:41], v22, s[44:47], s53 offen sc1
L_sdone:
    s_endpgm
L_T:
    s_setprio 3
    s_sub_u32 s3, s3, 4
    s_lshl_b32 s40, s91, 8
    s_lshl_b32 s41, s27, 19
    s_add_u32 s40, s40, s41
    s_sub_u32 s34, 0x400000, s40
    s_mov_b32 s35, 0x20000
    s_mov_b32 s38, 1024
    s_mov_b32 s39, 0x20000
    s_mov_b32 s30, 503808
    s_mov_b32 s31, 0x20000
    v_lshlrev_b32 v16, 4, v0
    v_and_b32 v17, 15, v0
    v_lshrrev_b32 v18, 4, v0
    v_lshlrev_b32 v1, 13, v18
    v_lshl_add_u32 v1, v17, 4, v1
    v_lshl_add_u32 v19, v17, 2, v18
    v_lshlrev_b32 v19, 1, v19
    s_lshl_b32 s41, s27, 7
    s_mov_b32 s42, 466944
    s_waitcnt lgkmcnt(0)
    s_mov_b32 s28, s24
    s_mov_b32 s29, s25
    s_mov_b32 s36, s4
    s_mov_b32 s37, s5
    s_add_u32 s32, s10, s40
    s_addc_u32 s33, s11, 0
    s_cmp_eq_u32 s3, 0
    s_cbranch_scc0 L_notq
    buffer_load_dwordx4 v[2:5], v16, s[36:39], 0 offen
    buffer_load_ushort v6, v19, s[36:39], s41 offen
    buffer_load_dword v63, off, s[28:31], s42 sc1
    s_mov_b32 s42, 0
    buffer_load_dwordx4 v[64:67], v1, s[32:35], s42 offen
    s_mov_b32 s42, 32768
    buffer_load_dwordx4 v[68:71], v1, s[32:35], s42 offen
    s_mov_b32 s42, 65536
    buffer_load_dwordx4 v[72:75], v1, s[32:35], s42 offen
    s_mov_b32 s42, 98304
    buffer_load_dwordx4 v[76:79], v1, s[32:35], s42 offen
    s_mov_b32 s42, 131072
    buffer_load_dwordx4 v[80:83], v1, s[32:35], s42 offen
    s_mov_b32 s42, 163840
    buffer_load_dwordx4 v[84:87], v1, s[32:35], s42 offen
    s_mov_b32 s42, 196608
    buffer_load_dwordx4 v[88:91], v1, s[32:35], s42 offen
    s_mov_b32 s42, 229376
    buffer_load_dwordx4 v[92:95], v1, s[32:35], s42 offen
    s_mov_b32 s42, 262144
    buffer_load_dwordx4 v[96:99], v1, s[32:35], s42 offen
    s_mov_b32 s42, 294912
    buffer_load_dwordx4 v[100:103], v1, s[32:35], s42 offen
    s_mov_b32 s42, 327680
    buffer_load_dwordx4 v[104:107], v1, s[32:35], s42 offen
    s_mov_b32 s42, 360448
    buffer_load_dwordx4 v[108:111], v1, s[32:35], s42 offen
    s_mov_b32 s42, 393216
    buffer_load_dwordx4 v[112:115], v1, s[32:35], s42 offen
    s_mov_b32 s42, 425984
    buffer_load_dwordx4 v[116:119], v1, s[32:35], s42 offen
    s_mov_b32 s42, 458752
    buffer_load_dwordx4 v[120:123], v1, s[32:35], s42 offen
    s_mov_b32 s42, 491520
    buffer_load_dwordx4 v[124:127], v1, s[32:35], s42 offen
    s_branch L_pf
L_notq:
    s_cmp_eq_u32 s27, 5
    s_cbranch_scc0 L_pf
    s_cmp_eq_u32 s3, 1
    s_cbranch_scc0 L_pf
    v_mov_b32 v192, -1
    v_mov_b32 v193, -1
    v_mov_b32 v194, -1
    v_mov_b32 v195, -1
    s_mul_i32 s43, s26, 6400
    buffer_store_dwordx4 v[192:195], v16, s[28:31], s43 offen offset:0 sc1
    buffer_store_dwordx4 v[192:195], v16, s[28:31], s43 offen offset:1024 sc1
    buffer_store_dwordx4 v[192:195], v16, s[28:31], s43 offen offset:2048 sc1
    buffer_store_dwordx4 v[192:195], v16, s[28:31], s43 offen offset:3072 sc1
    s_add_u32 s43, s43, 4096
    buffer_store_dwordx4 v[192:195], v16, s[28:31], s43 offen offset:0 sc1
    buffer_store_dwordx4 v[192:195], v16, s[28:31], s43 offen offset:1024 sc1
    s_mov_b64 exec, 0xffff
    buffer_store_dwordx4 v[192:195], v16, s[28:31], s43 offen offset:2048 sc1
    s_mov_b32 s44, s22
    s_mov_b32 s45, s23
    s_mov_b32 s46, 256
    s_mov_b32 s47, 0x20000
    s_lshl_b32 s40, s26, 2
    s_waitcnt vmcnt(0)
    s_mov_b64 exec, 1
    buffer_store_dword v192, off, s[44:47], s40 sc1
    s_mov_b64 exec, -1
L_pf:
    s_cmp_lt_u32 s2, 64
    s_cbranch_scc1 L_pfdone
    s_cmp_eq_u32 s3, 0
    s_cbranch_scc1 L_pfdone
    s_lshr_b32 s53, s2, 3
    s_cmp_lt_u32 s2, 128
    s_cbranch_scc0 L_pfhi
    s_cmp_eq_u32 s3, 1
    s_cbranch_scc1 L_pfdone
    s_lshl_b32 s53, s53, 1
    s_add_u32 s53, s53, 30
    s_branch L_pfj
L_pfhi:
    s_mul_i32 s53, s53, 3
    s_sub_u32 s53, s53, 49
L_pfj:
    s_add_u32 s53, s53, s3
    s_lshr_b32 s40, s53, 4
    s_lshl_b32 s40, s40, 3
    s_and_b32 s55, s2, 7
    s_add_u32 s55, s55, s40
    s_bfe_u32 s40, s55, 0x10000
    s_bfe_u32 s54, s55, 0x20003
    s_lshl_b32 s54, s54, 1
    s_or_b32 s40, s40, s54
    s_bfe_u32 s54, s55, 0x10002
    s_lshl_b32 s54, s54, 3
    s_or_b32 s40, s40, s54
    s_bfe_u32 s54, s55, 0x10001
    s_lshl_b32 s54, s54, 4
    s_or_b32 s40, s40, s54
    s_lshl_b32 s40, s40, 17
    s_and_b32 s53, s53, 15
    s_lshl_b32 s53, s53, 13
    s_add_u32 s40, s40, s53
    s_mov_b32 s44, s12
    s_mov_b32 s45, s13
    s_mov_b32 s46, 4194304
    s_mov_b32 s47, 0x20000
    v_lshlrev_b32 v22, 7, v0
    buffer_load_dword v196, v22, s[44:47], s40 offen
L_pfdone:
    s_cmp_eq_u32 s3, 0
    s_cbranch_scc0 L_bar1
    v_and_b32 v20, 1, v0
    v_lshlrev_b32 v20, 4, v20
    v_mov_b32 v21, 0xffff
    v_lshlrev_b32 v20, v20, v21
    v_bfe_u32 v21, v0, 1, 3
    v_cmp_eq_u32 vcc, 0, v21
    s_nop 1
    v_cndmask_b32 v32, 0, v20, vcc
    v_cmp_eq_u32 vcc, 1, v21
    s_nop 1
    v_cndmask_b32 v33, 0, v20, vcc
    v_cmp_eq_u32 vcc, 2, v21
    s_nop 1
    v_cndmask_b32 v34, 0, v20, vcc
    v_cmp_eq_u32 vcc, 3, v21
    s_nop 1
    v_cndmask_b32 v35, 0, v20, vcc
    v_mov_b32 v20, -1
    v_lshlrev_b32 v21, 2, v17
    ds_write_b32 v21, v20 offset:4096
    s_waitcnt vmcnt(16)
    v_lshlrev_b32 v8, 16, v2
    v_and_b32 v9, 0xffff0000, v2
    v_lshlrev_b32 v10, 16, v3
    v_and_b32 v11, 0xffff0000, v3
    v_lshlrev_b32 v12, 16, v4
    v_and_b32 v13, 0xffff0000, v4
    v_lshlrev_b32 v14, 16, v5
    v_and_b32 v15, 0xffff0000, v5
    v_readfirstlane_b32 s43, v8
    s_nop 1
    v_subrev_f32 v20, s43, v8
    v_subrev_f32 v21, s43, v9
    v_subrev_f32 v22, s43, v10
    v_subrev_f32 v23, s43, v11
    v_subrev_f32 v24, s43, v12
    v_subrev_f32 v25, s43, v13
    v_subrev_f32 v26, s43, v14
    v_subrev_f32 v27, s43, v15
    v_add_f32 v28, v20, v21
    v_mul_f32 v29, v20, v20
    v_add_f32 v30, v22, v23
    v_mul_f32 v31, v21, v21
    v_add_f32 v28, v28, v24
    v_fmac_f32 v29, v22, v22
    v_add_f32 v30, v30, v25
    v_fmac_f32 v31, v23, v23
    v_add_f32 v28, v28, v26
    v_fmac_f32 v29, v24, v24
    v_add_f32 v30, v30, v27
    v_fmac_f32 v31, v25, v25
    v_fmac_f32 v29, v26, v26
    v_fmac_f32 v31, v27, v27
    v_add_f32 v28, v28, v30
    v_add_f32 v29, v29, v31
    s_nop 0
    v_add_f32_dpp v28, v28, v28 quad_perm:[1,0,3,2] row_mask:0xf bank_mask:0xf
    v_add_f32_dpp v29, v29, v29 quad_perm:[1,0,3,2] row_mask:0xf bank_mask:0xf
    s_nop 0
    v_add_f32_dpp v28, v28, v28 quad_perm:[2,3,0,1] row_mask:0xf bank_mask:0xf
    v_add_f32_dpp v29, v29, v29 quad_perm:[2,3,0,1] row_mask:0xf bank_mask:0xf
    s_nop 0
    v_add_f32_dpp v28, v28, v28 row_half_mirror row_mask:0xf bank_mask:0xf
    v_add_f32_dpp v29, v29, v29 row_half_mirror row_mask:0xf bank_mask:0xf
    s_nop 0
    v_add_f32_dpp v28, v28, v28 row_mirror row_mask:0xf bank_mask:0xf
    v_add_f32_dpp v29, v29, v29 row_mirror row_mask:0xf bank_mask:0xf
    v_mov_b32 v30, v28
    v_mov_b32 v31, v29
    s_nop 0
    v_permlane16_swap_b32 v28, v30
    v_permlane16_swap_b32 v29, v31
    v_add_f32 v28, v28, v30
    v_add_f32 v29, v29, v31
    v_mov_b32 v30, v28
    v_mov_b32 v31, v29
    s_nop 0
    v_permlane32_swap_b32 v28, v30
    v_permlane32_swap_b32 v29, v31
    v_add_f32 v28, v28, v30
    v_add_f32 v29, v29, v31
    v_mul_f32 v30, 0x3b000000, v28
    v_mul_f32 v31, 0x3b000000, v29
    v_fma_f32 v31, -v30, v30, v31
    v_add_f32 v50, s43, v30
    v_max_f32 v31, 0, v31
    v_cvt_pk_bf16_f32 v31, v31, v31
    v_and_b32 v31, 0xffff0000, v31
    v_add_f32 v31, 0x3727c5ac, v31
    v_cvt_pk_bf16_f32 v31, v31, v31
    v_and_b32 v31, 0xffff0000, v31
    v_sqrt_f32 v31, v31
    v_cvt_pk_bf16_f32 v50, v50, v50
    v_and_b32 v50, 0xffff0000, v50
    v_cvt_pk_bf16_f32 v31, v31, v31
    v_and_b32 v31, 0xffff0000, v31
    v_rcp_f32 v51, v31
    v_lshlrev_b32 v6, 16, v6
    v_sub_f32 v6, v6, v50
    v_cvt_pk_bf16_f32 v6, v6, v6
    v_and_b32 v6, 0xffff0000, v6
    v_mul_f32 v6, v6, v51
    v_cvt_pk_bf16_f32 v36, v6, v6
    s_mov_b32 s40, 0x9e3779b1
    v_mul_lo_u32 v63, v63, s40
    v_add_u32 v63, 0x7f4a7c15, v63
    v_and_b32_dpp v38, v36, v32 row_newbcast:0 row_mask:0xf bank_mask:0xf
    v_and_b32_dpp v39, v36, v33 row_newbcast:0 row_mask:0xf bank_mask:0xf
    v_and_b32_dpp v40, v36, v34 row_newbcast:0 row_mask:0xf bank_mask:0xf
    v_and_b32_dpp v41, v36, v35 row_newbcast:0 row_mask:0xf bank_mask:0xf
    v_and_b32_dpp v42, v36, v32 row_newbcast:1 row_mask:0xf bank_mask:0xf
    v_and_b32_dpp v43, v36, v33 row_newbcast:1 row_mask:0xf bank_mask:0xf
    v_and_b32_dpp v44, v36, v34 row_newbcast:1 row_mask:0xf bank_mask:0xf
    v_and_b32_dpp v45, v36, v35 row_newbcast:1 row_mask:0xf bank_mask:0xf
    s_waitcnt vmcnt(15)
    v_mfma_f32_16x16x32_bf16 v[46:49], v[38:41], v[64:67], 0
    v_and_b32_dpp v38, v36, v32 row_newbcast:2 row_mask:0xf bank_mask:0xf
    v_and_b32_dpp v39, v36, v33 row_newbcast:2 row_mask:0xf bank_mask:0xf
    v_and_b32_dpp v40, v36, v34 row_newbcast:2 row_mask:0xf bank_mask:0xf
    v_and_b32_dpp v41, v36, v35 row_newbcast:2 row_mask:0xf bank_mask:0xf
    s_waitcnt vmcnt(14)
    v_mfma_f32_16x16x32_bf16 v[46:49], v[42:45], v[68:71], v[46:49]
    v_and_b32_dpp v42, v36, v32 row_newbcast:3 row_mask:0xf bank_mask:0xf
    v_and_b32_dpp v43, v36, v33 row_newbcast:3 row_mask:0xf bank_mask:0xf
    v_and_b32_dpp v44, v36, v34 row_newbcast:3 row_mask:0xf bank_mask:0xf
    v_and_b32_dpp v45, v36, v35 row_newbcast:3 row_mask:0xf bank_mask:0xf
    s_waitcnt vmcnt(13)
    v_mfma_f32_16x16x32_bf16 v[46:49], v[38:41], v[72:75], v[46:49]
    v_and_b32_dpp v38, v36, v32 row_newbcast:4 row_mask:0xf bank_mask:0xf
    v_and_b32_dpp v39, v36, v33 row_newbcast:4 row_mask:0xf bank_mask:0xf
    v_and_b32_dpp v40, v36, v34 row_newbcast:4 row_mask:0xf bank_mask:0xf
    v_and_b32_dpp v41, v36, v35 row_newbcast:4 row_mask:0xf bank_mask:0xf
    s_waitcnt vmcnt(12)
    v_mfma_f32_16x16x32_bf16 v[46:49], v[42:45], v[76:79], v[46:49]
    v_and_b32_dpp v42, v36, v32 row_newbcast:5 row_mask:0xf bank_mask:0xf
    v_and_b32_dpp v43, v36, v33 row_newbcast:5 row_mask:0xf bank_mask:0xf
    v_and_b32_dpp v44, v36, v34 row_newbcast:5 row_mask:0xf bank_mask:0xf
    v_and_b32_dpp v45, v36, v35 row_newbcast:5 row_mask:0xf bank_mask:0xf
    s_waitcnt vmcnt(11)
    v_mfma_f32_16x16x32_bf16 v[46:49], v[38:41], v[80:83], v[46:49]
    v_and_b32_dpp v38, v36, v32 row_newbcast:6 row_mask:0xf bank_mask:0xf
    v_and_b32_dpp v39, v36, v33 row_newbcast:6 row_mask:0xf bank_mask:0xf
    v_and_b32_dpp v40, v36, v34 row_newbcast:6 row_mask:0xf bank_mask:0xf
    v_and_b32_dpp v41, v36, v35 row_newbcast:6 row_mask:0xf bank_mask:0xf
    s_waitcnt vmcnt(10)
    v_mfma_f32_16x16x32_bf16 v[46:49], v[42:45], v[84:87], v[46:49]
    v_and_b32_dpp v42, v36, v32 row_newbcast:7 row_mask:0xf bank_mask:0xf
    v_and_b32_dpp v43, v36, v33 row_newbcast:7 row_mask:0xf bank_mask:0xf
    v_and_b32_dpp v44, v36, v34 row_newbcast:7 row_mask:0xf bank_mask:0xf
    v_and_b32_dpp v45, v36, v35 row_newbcast:7 row_mask:0xf bank_mask:0xf
    s_waitcnt vmcnt(9)
    v_mfma_f32_16x16x32_bf16 v[46:49], v[38:41], v[88:91], v[46:49]
    v_and_b32_dpp v38, v36, v32 row_newbcast:8 row_mask:0xf bank_mask:0xf
    v_and_b32_dpp v39, v36, v33 row_newbcast:8 row_mask:0xf bank_mask:0xf
    v_and_b32_dpp v40, v36, v34 row_newbcast:8 row_mask:0xf bank_mask:0xf
    v_and_b32_dpp v41, v36, v35 row_newbcast:8 row_mask:0xf bank_mask:0xf
    s_waitcnt vmcnt(8)
    v_mfma_f32_16x16x32_bf16 v[46:49], v[42:45], v[92:95], v[46:49]
    v_and_b32_dpp v42, v36, v32 row_newbcast:9 row_mask:0xf bank_mask:0xf
    v_and_b32_dpp v43, v36, v33 row_newbcast:9 row_mask:0xf bank_mask:0xf
    v_and_b32_dpp v44, v36, v34 row_newbcast:9 row_mask:0xf bank_mask:0xf
    v_and_b32_dpp v45, v36, v35 row_newbcast:9 row_mask:0xf bank_mask:0xf
    s_waitcnt vmcnt(7)
    v_mfma_f32_16x16x32_bf16 v[46:49], v[38:41], v[96:99], v[46:49]
    v_and_b32_dpp v38, v36, v32 row_newbcast:10 row_mask:0xf bank_mask:0xf
    v_and_b32_dpp v39, v36, v33 row_newbcast:10 row_mask:0xf bank_mask:0xf
    v_and_b32_dpp v40, v36, v34 row_newbcast:10 row_mask:0xf bank_mask:0xf
    v_and_b32_dpp v41, v36, v35 row_newbcast:10 row_mask:0xf bank_mask:0xf
    s_waitcnt vmcnt(6)
    v_mfma_f32_16x16x32_bf16 v[46:49], v[42:45], v[100:103], v[46:49]
    v_and_b32_dpp v42, v36, v32 row_newbcast:11 row_mask:0xf bank_mask:0xf
    v_and_b32_dpp v43, v36, v33 row_newbcast:11 row_mask:0xf bank_mask:0xf
    v_and_b32_dpp v44, v36, v34 row_newbcast:11 row_mask:0xf bank_mask:0xf
    v_and_b32_dpp v45, v36, v35 row_newbcast:11 row_mask:0xf bank_mask:0xf
    s_waitcnt vmcnt(5)
    v_mfma_f32_16x16x32_bf16 v[46:49], v[38:41], v[104:107], v[46:49]
    v_and_b32_dpp v38, v36, v32 row_newbcast:12 row_mask:0xf bank_mask:0xf
    v_and_b32_dpp v39, v36, v33 row_newbcast:12 row_mask:0xf bank_mask:0xf
    v_and_b32_dpp v40, v36, v34 row_newbcast:12 row_mask:0xf bank_mask:0xf
    v_and_b32_dpp v41, v36, v35 row_newbcast:12 row_mask:0xf bank_mask:0xf
    s_waitcnt vmcnt(4)
    v_mfma_f32_16x16x32_bf16 v[46:49], v[42:45], v[108:111], v[46:49]
    v_and_b32_dpp v42, v36, v32 row_newbcast:13 row_mask:0xf bank_mask:0xf
    v_and_b32_dpp v43, v36, v33 row_newbcast:13 row_mask:0xf bank_mask:0xf
    v_and_b32_dpp v44, v36, v34 row_newbcast:13 row_mask:0xf bank_mask:0xf
    v_and_b32_dpp v45, v36, v35 row_newbcast:13 row_mask:0xf bank_mask:0xf
    s_waitcnt vmcnt(3)
    v_mfma_f32_16x16x32_bf16 v[46:49], v[38:41], v[112:115], v[46:49]
    v_and_b32_dpp v38, v36, v32 row_newbcast:14 row_mask:0xf bank_mask:0xf
    v_and_b32_dpp v39, v36, v33 row_newbcast:14 row_mask:0xf bank_mask:0xf
    v_and_b32_dpp v40, v36, v34 row_newbcast:14 row_mask:0xf bank_mask:0xf
    v_and_b32_dpp v41, v36, v35 row_newbcast:14 row_mask:0xf bank_mask:0xf
    s_waitcnt vmcnt(2)
    v_mfma_f32_16x16x32_bf16 v[46:49], v[42:45], v[116:119], v[46:49]
    v_and_b32_dpp v42, v36, v32 row_newbcast:15 row_mask:0xf bank_mask:0xf
    v_and_b32_dpp v43, v36, v33 row_newbcast:15 row_mask:0xf bank_mask:0xf
    v_and_b32_dpp v44, v36, v34 row_newbcast:15 row_mask:0xf bank_mask:0xf
    v_and_b32_dpp v45, v36, v35 row_newbcast:15 row_mask:0xf bank_mask:0xf
    s_waitcnt vmcnt(1)
    v_mfma_f32_16x16x32_bf16 v[46:49], v[38:41], v[120:123], v[46:49]
    s_waitcnt vmcnt(0)
    v_mfma_f32_16x16x32_bf16 v[46:49], v[42:45], v[124:127], v[46:49]
    s_lshl_b32 s40, s26, 13
    s_add_u32 s40, s40, 204800
    s_lshl_b32 s41, s27, 10
    s_add_u32 s41, s41, s40
    s_add_u32 s42, s40, 4096
    s_nop 2
    v_permlane32_swap_b32 v46, v48
    v_permlane32_swap_b32 v47, v49
    v_mov_b32 v48, v47
    v_mov_b32 v47, v63
    v_mov_b32 v49, v63
    buffer_store_dwordx4 v[46:49], v16, s[28:31], s41 offen sc1
    s_cmp_lt_u32 s2, 64
    s_cbranch_scc0 L_noxi
    s_getreg_b32 s15, hwreg(HW_REG_XCC_ID, 0, 4)
    s_and_b32 s41, s2, 7
    s_lshl_b32 s41, s41, 7
    s_and_b32 s43, s2, 0x38
    s_add_u32 s41, s41, s43
    s_add_u32 s41, s41, 467968
    v_mov_b32 v62, s15
    s_mov_b64 exec, 1
    buffer_store_dwordx2 v[62:63], off, s[28:31], s41 sc1
    s_mov_b64 exec, -1
L_noxi:
    v_and_b32 v20, 1, v18
    v_lshlrev_b32 v20, 3, v20
    v_lshl_add_u32 v20, v17, 4, v20
    v_lshrrev_b32 v21, 1, v18
    v_lshl_add_u32 v20, v21, 2, v20
    s_mov_b32 s43, 262144
    s_waitcnt vmcnt(0)
L_qx:
    s_sleep 24
    buffer_load_dwordx4 v[64:67], v16, s[28:31], s40 offen offset:0 sc1
    buffer_load_dwordx4 v[68:71], v16, s[28:31], s40 offen offset:1024 sc1
    buffer_load_dwordx4 v[72:75], v16, s[28:31], s40 offen offset:2048 sc1
    buffer_load_dwordx4 v[76:79], v16, s[28:31], s40 offen offset:3072 sc1
    buffer_load_dwordx4 v[80:83], v16, s[28:31], s42 offen offset:0 sc1
    buffer_load_dwordx4 v[84:87], v16, s[28:31], s42 offen offset:1024 sc1
    buffer_load_dwordx4 v[88:91], v16, s[28:31], s42 offen offset:2048 sc1
    buffer_load_dwordx4 v[92:95], v16, s[28:31], s42 offen offset:3072 sc1
    s_waitcnt vmcnt(0)
    v_xor_b32 v65, v65, v63
    v_xor_b32 v67, v67, v63
    v_xor_b32 v69, v69, v63
    v_xor_b32 v71, v71, v63
    v_xor_b32 v73, v73, v63
    v_xor_b32 v75, v75, v63
    v_xor_b32 v77, v77, v63
    v_xor_b32 v79, v79, v63
    v_xor_b32 v81, v81, v63
    v_xor_b32 v83, v83, v63
    v_xor_b32 v85, v85, v63
    v_xor_b32 v87, v87, v63
    v_xor_b32 v89, v89, v63
    v_xor_b32 v91, v91, v63
    v_xor_b32 v93, v93, v63
    v_xor_b32 v95, v95, v63
    v_or_b32 v21, v65, v67
    v_or3_b32 v21, v21, v69, v71
    v_or3_b32 v21, v21, v73, v75
    v_or3_b32 v21, v21, v77, v79
    v_or3_b32 v21, v21, v81, v83
    v_or3_b32 v21, v21, v85, v87
    v_or3_b32 v21, v21, v89, v91
    v_or3_b32 v21, v21, v93, v95
    s_sub_u32 s43, s43, 1
    s_cbranch_scc1 L_qx_done
    v_cmp_ne_u32 vcc, 0, v21
    s_cbranch_vccnz L_qx
L_qx_done:
    v_add_f32 v64, v64, v68
    v_add_f32 v66, v66, v70
    v_add_f32 v72, v72, v76
    v_add_f32 v74, v74, v78
    v_add_f32 v80, v80, v84
    v_add_f32 v82, v82, v86
    v_add_f32 v88, v88, v92
    v_add_f32 v90, v90, v94
    v_add_f32 v64, v64, v72
    v_add_f32 v66, v66, v74
    v_add_f32 v80, v80, v88
    v_add_f32 v82, v82, v90
    v_add_f32 v64, v64, v80
    v_add_f32 v66, v66, v82
    v_cvt_pk_bf16_f32 v64, v64, v66
    ds_write_b32 v20, v64 offset:0
    s_waitcnt lgkmcnt(0)
L_bar1:
    s_barrier
    s_lshr_b32 s40, s2, 3
    s_cmp_eq_u32 s40, 15
    s_cselect_b32 s27, 7, s27
    s_cmp_lt_u32 s27, 4
    s_cbranch_scc1 L_keep
    s_cmp_gt_u32 s3, 0
    s_cbranch_scc1 L_end
L_keep:
    s_mov_b32 s44, s22
    s_mov_b32 s45, s23
    s_mov_b32 s46, 256
    s_mov_b32 s47, 0x20000
L_noreset:
    v_lshlrev_b32 v56, 3, v0
    v_and_b32 v57, 56, v56
    s_branch L_setup
L_waitk:
    v_and_b32 v27, 31, v0
    v_lshlrev_b32 v27, 2, v27
    s_mov_b32 s43, 262144
    s_nop 0
L_pollflag:
    buffer_load_dword v22, v27, s[44:47], 0 offen sc1
    s_sub_u32 s43, s43, 1
    s_cbranch_scc1 L_pollflag_done
    s_waitcnt vmcnt(0)
    v_cmp_eq_u32 vcc, 0, v22
    s_cbranch_vccz L_pollflag_done
    s_sleep 8
    s_branch L_pollflag
L_pollflag_done:
    s_waitcnt vmcnt(0)
    s_mov_b32 s43, 262144
    v_and_b32 v26, 24, v56
    s_nop 1
L_pollml:
    s_sleep 8
    ds_read_b64 v[60:61], v26 offset:4096
    s_sub_u32 s43, s43, 1
    s_cbranch_scc1 L_pollml_done
    s_waitcnt lgkmcnt(0)
    v_cmp_u_f32 vcc, v60, v61
    s_cbranch_vccnz L_pollml
L_pollml_done:
    s_waitcnt lgkmcnt(0)
    s_lshr_b32 s41, s2, 5
    s_lshl_b32 s14, s26, 7
    s_lshl_b32 s53, s41, 3
    s_add_u32 s53, s53, s14
    s_lshl_b32 s54, s26, 3
    s_add_u32 s54, s54, s41
    s_lshl_b32 s54, s54, 8
    s_add_u32 s54, s54, 20480
    v_max_f32_dpp v24, v60, v60 quad_perm:[1,0,3,2] row_mask:0xf bank_mask:0xf
    s_nop 1
    v_max_f32_dpp v24, v24, v24 quad_perm:[2,3,0,1] row_mask:0xf bank_mask:0xf
    v_sub_f32 v22, v60, v24
    v_mul_f32 v22, 0x3fb8aa3b, v22
    v_exp_f32 v22, v22
    s_nop 0
    v_mul_f32 v25, v22, v61
    s_nop 1
    v_add_f32_dpp v25, v25, v25 quad_perm:[1,0,3,2] row_mask:0xf bank_mask:0xf
    s_nop 1
    v_add_f32_dpp v25, v25, v25 quad_perm:[2,3,0,1] row_mask:0xf bank_mask:0xf
    s_mov_b64 exec, 1
    buffer_store_dwordx2 v[24:25], off, s[28:31], s53 sc1
    s_mov_b64 exec, -1
    s_and_b32 s40, s26, 7
    s_lshl_b32 s40, s40, 7
    s_add_u32 s40, s40, 467968
    buffer_load_dwordx2 v[26:27], v57, s[28:31], s40 offen sc1
    s_getreg_b32 s15, hwreg(HW_REG_XCC_ID, 0, 4)
    s_waitcnt vmcnt(0)
    v_cmp_ne_u32 s[86:87], s15, v26
    v_cmp_ne_u32 vcc, v63, v27
    s_nop 0
    s_or_b64 s[86:87], s[86:87], vcc
    s_branch L_head
    s_nop 1
L_setup:
    s_waitcnt vmcnt(0)
    v_mov_b32 v53, 0
    v_mov_b32 v54, 0
    v_mov_b32 v58, 0
    v_mov_b32 v59, 0
    v_mov_b32 v9, 0
    s_lshl_b32 s58, s3, 14
    s_add_u32 s58, s58, 8192
    v_add_u32 v34, s58, v16
    v_mov_b32 v32, 0
    v_mov_b32 v33, 0
    v_mov_b32 v35, 0
    v_mov_b32 v36, 0
    s_mov_b32 s7, 0x20000
    v_lshrrev_b32 v21, 2, v0
    v_and_b32 v22, 3, v0
    s_cmp_lt_u32 s27, 2
    s_cbranch_scc1 L_setB
    s_cmp_lt_u32 s27, 4
    s_cbranch_scc1 L_setC
    s_cmp_eq_u32 s27, 4
    s_cbranch_scc0 L_setdone
    v_lshl_add_u32 v23, v18, 4, v22
    s_lshr_b32 s40, s26, 2
    s_lshl_b32 s40, s40, 6
    s_and_b32 s41, s26, 3
    s_lshl_b32 s41, s41, 2
    s_add_u32 s40, s40, s41
    v_add_u32 v23, s40, v23
    v_lshlrev_b32 v54, 1, v23
    buffer_load_ushort v8, v54, s[36:39], 0 offen
    v_and_b32 v24, 3, v21
    v_lshlrev_b32 v24, 11, v24
    v_lshl_add_u32 v9, v23, 2, v24
    v_lshlrev_b32 v53, 11, v21
    v_lshl_add_u32 v53, v22, 4, v53
    s_add_u32 s32, s24, 86016
    s_addc_u32 s33, s25, 0
    s_mov_b32 s34, 114688
    s_waitcnt vmcnt(0)
    v_lshlrev_b32 v8, 16, v8
    s_branch L_setdone
L_setB:
    s_and_b32 s55, s2, 7
    s_lshr_b32 s56, s2, 3
    s_lshl_b32 s40, s3, 3
    s_add_u32 s40, s40, s55
    s_lshl_b32 s59, s40, 11
    s_add_u32 s59, s59, 20480
    s_mov_b32 s42, s40
    s_bfe_u32 s40, s42, 0x10000
    s_bfe_u32 s41, s42, 0x20003
    s_lshl_b32 s41, s41, 1
    s_or_b32 s40, s40, s41
    s_bfe_u32 s41, s42, 0x10002
    s_lshl_b32 s41, s41, 3
    s_or_b32 s40, s40, s41
    s_bfe_u32 s41, s42, 0x10001
    s_lshl_b32 s41, s41, 4
    s_or_b32 s40, s40, s41
    s_lshl_b32 s40, s40, 17
    s_lshl_b32 s41, s56, 7
    s_add_u32 s40, s40, s41
    s_add_u32 s32, s12, s40
    s_addc_u32 s33, s13, 0
    s_sub_u32 s34, 0x400000, s40
    v_and_b32 v24, 7, v0
    v_lshrrev_b32 v32, 3, v0
    v_lshlrev_b32 v32, 10, v32
    v_lshl_add_u32 v32, v24, 4, v32
    s_mov_b32 s42, 0
    buffer_load_dwordx4 v[128:131], v32, s[32:35], s42 offen
    s_mov_b32 s42, 8192
    buffer_load_dwordx4 v[132:135], v32, s[32:35], s42 offen
    s_mov_b32 s42, 16384
    buffer_load_dwordx4 v[136:139], v32, s[32:35], s42 offen
    s_mov_b32 s42, 24576
    buffer_load_dwordx4 v[140:143], v32, s[32:35], s42 offen
    s_mov_b32 s42, 32768
    buffer_load_dwordx4 v[144:147], v32, s[32:35], s42 offen
    s_mov_b32 s42, 40960
    buffer_load_dwordx4 v[148:151], v32, s[32:35], s42 offen
    s_mov_b32 s42, 49152
    buffer_load_dwordx4 v[152:155], v32, s[32:35], s42 offen
    s_mov_b32 s42, 57344
    buffer_load_dwordx4 v[156:159], v32, s[32:35], s42 offen
    s_mov_b32 s42, 65536
    buffer_load_dwordx4 v[160:163], v32, s[32:35], s42 offen
    s_mov_b32 s42, 73728
    buffer_load_dwordx4 v[164:167], v32, s[32:35], s42 offen
    s_mov_b32 s42, 81920
    buffer_load_dwordx4 v[168:171], v32, s[32:35], s42 offen
    s_mov_b32 s42, 90112
    buffer_load_dwordx4 v[172:175], v32, s[32:35], s42 offen
    s_mov_b32 s42, 98304
    buffer_load_dwordx4 v[176:179], v32, s[32:35], s42 offen
    s_mov_b32 s42, 106496
    buffer_load_dwordx4 v[180:183], v32, s[32:35], s42 offen
    s_mov_b32 s42, 114688
    buffer_load_dwordx4 v[184:187], v32, s[32:35], s42 offen
    s_mov_b32 s42, 122880
    buffer_load_dwordx4 v[188:191], v32, s[32:35], s42 offen
    s_lshl_b32 s57, s55, 11
    s_lshl_b32 s40, s56, 8
    s_add_u32 s57, s57, s40
    s_add_u32 s57, s57, 4096
    v_lshlrev_b32 v53, 8, v24
    v_lshl_add_u32 v53, v18, 4, v53
    s_lshl_b32 s40, s3, 2
    v_add_u32 v54, s40, v16
    v_bfe_u32 v35, v0, 2, 2
    v_lshl_add_u32 v35, v18, 3, v35
    v_lshlrev_b32 v35, 7, v35
    v_lshl_add_u32 v35, v22, 3, v35
    v_add_u32 v35, s58, v35
    s_waitcnt vmcnt(15)
    ds_write_b128 v34, v[128:131] offset:0
    s_waitcnt vmcnt(14)
    ds_write_b128 v34, v[132:135] offset:1024
    s_waitcnt vmcnt(13)
    ds_write_b128 v34, v[136:139] offset:2048
    s_waitcnt vmcnt(12)
    ds_write_b128 v34, v[140:143] offset:3072
    s_waitcnt vmcnt(11)
    ds_write_b128 v34, v[144:147] offset:4096
    s_waitcnt vmcnt(10)
    ds_write_b128 v34, v[148:151] offset:5120
    s_waitcnt vmcnt(9)
    ds_write_b128 v34, v[152:155] offset:6144
    s_waitcnt vmcnt(8)
    ds_write_b128 v34, v[156:159] offset:7168
    s_waitcnt vmcnt(7)
    ds_write_b128 v34, v[160:163] offset:8192
    s_waitcnt vmcnt(6)
    ds_write_b128 v34, v[164:167] offset:9216
    s_waitcnt vmcnt(5)
    ds_write_b128 v34, v[168:171] offset:10240
    s_waitcnt vmcnt(4)
    ds_write_b128 v34, v[172:175] offset:11264
    s_waitcnt vmcnt(3)
    ds_write_b128 v34, v[176:179] offset:12288
    s_waitcnt vmcnt(2)
    ds_write_b128 v34, v[180:183] offset:13312
    s_waitcnt vmcnt(1)
    ds_write_b128 v34, v[184:187] offset:14336
    s_waitcnt vmcnt(0)
    ds_write_b128 v34, v[188:191] offset:15360
    s_waitcnt lgkmcnt(0)
    ds_read_b64_tr_b16 v[64:65], v35 offset:0
    ds_read_b64_tr_b16 v[66:67], v35 offset:512
    ds_read_b64_tr_b16 v[68:69], v35 offset:32
    ds_read_b64_tr_b16 v[70:71], v35 offset:544
    ds_read_b64_tr_b16 v[72:73], v35 offset:64
    ds_read_b64_tr_b16 v[74:75], v35 offset:576
    ds_read_b64_tr_b16 v[76:77], v35 offset:96
    ds_read_b64_tr_b16 v[78:79], v35 offset:608
    s_waitcnt lgkmcnt(4)
    ds_read_b64_tr_b16 v[80:81], v35 offset:4096
    ds_read_b64_tr_b16 v[82:83], v35 offset:4608
    ds_read_b64_tr_b16 v[84:85], v35 offset:4128
    ds_read_b64_tr_b16 v[86:87], v35 offset:4640
    ds_read_b64_tr_b16 v[88:89], v35 offset:4160
    ds_read_b64_tr_b16 v[90:91], v35 offset:4672
    ds_read_b64_tr_b16 v[92:93], v35 offset:4192
    ds_read_b64_tr_b16 v[94:95], v35 offset:4704
    s_waitcnt lgkmcnt(4)
    ds_read_b64_tr_b16 v[96:97], v35 offset:8192
    ds_read_b64_tr_b16 v[98:99], v35 offset:8704
    ds_read_b64_tr_b16 v[100:101], v35 offset:8224
    ds_read_b64_tr_b16 v[102:103], v35 offset:8736
    ds_read_b64_tr_b16 v[104:105], v35 offset:8256
    ds_read_b64_tr_b16 v[106:107], v35 offset:8768
    ds_read_b64_tr_b16 v[108:109], v35 offset:8288
    ds_read_b64_tr_b16 v[110:111], v35 offset:8800
    s_waitcnt lgkmcnt(4)
    ds_read_b64_tr_b16 v[112:113], v35 offset:12288
    ds_read_b64_tr_b16 v[114:115], v35 offset:12800
    ds_read_b64_tr_b16 v[116:117], v35 offset:12320
    ds_read_b64_tr_b16 v[118:119], v35 offset:12832
    ds_read_b64_tr_b16 v[120:121], v35 offset:12352
    ds_read_b64_tr_b16 v[122:123], v35 offset:12864
    ds_read_b64_tr_b16 v[124:125], v35 offset:12384
    ds_read_b64_tr_b16 v[126:127], v35 offset:12896
    s_waitcnt lgkmcnt(0)
    s_branch L_setdone
L_setC:
    s_and_b32 s56, s2, 7
    s_mul_i32 s56, s56, 7
    s_lshr_b32 s40, s2, 3
    s_sub_u32 s40, s40, 8
    s_add_u32 s56, s56, s40
    s_lshl_b32 s40, s3, 2
    s_lshl_b32 s41, s3, 4
    v_lshl_add_u32 v53, v18, 2, v22
    v_add_u32 v53, s41, v53
    v_lshlrev_b32 v25, 4, v53
    buffer_load_dwordx4 v[2:5], v25, s[36:39], 0 offen
    v_lshlrev_b32 v53, 5, v53
    v_bfe_u32 v25, v0, 2, 2
    v_lshl_add_u32 v53, v25, 11, v53
    v_and_b32 v54, 31, v0
    v_lshlrev_b32 v54, 4, v54
    v_add_u32 v54, s40, v54
    v_and_b32 v58, 7, v0
    v_lshl_add_u32 v58, v18, 3, v58
    v_lshlrev_b32 v58, 4, v58
    v_lshrrev_b32 v59, 5, v0
    v_lshlrev_b32 v59, 4, v59
    v_add_u32 v59, s40, v59
    s_mul_i32 s40, s3, 458752
    s_lshl_b32 s41, s56, 6
    s_add_u32 s40, s40, s41
    s_add_u32 s32, s16, s40
    s_addc_u32 s33, s17, 0
    s_sub_u32 s34, 1835008, s40
    v_mul_u32_u24 v32, 3584, v21
    v_lshl_add_u32 v32, v22, 4, v32
    s_lshl_b32 s40, s56, 15
    s_lshl_b32 s41, s3, 8
    s_add_u32 s40, s40, s41
    s_add_u32 s4, s18, s40
    s_addc_u32 s5, s19, 0
    s_sub_u32 s6, 1835008, s40
    v_lshlrev_b32 v33, 10, v18
    v_lshl_add_u32 v33, v17, 4, v33
    s_lshl_b32 s57, s56, 11
    s_lshl_b32 s40, s3, 9
    s_add_u32 s57, s57, s40
    s_add_u32 s57, s57, 86016
    v_lshl_add_u32 v35, v18, 5, v25
    v_lshlrev_b32 v35, 6, v35
    v_lshl_add_u32 v35, v22, 3, v35
    v_add_u32 v35, s58, v35
    v_lshl_add_u32 v36, v18, 3, v25
    v_lshlrev_b32 v36, 8, v36
    v_lshl_add_u32 v36, v22, 3, v36
    v_add_u32 v36, s58, v36
    s_mov_b32 s84, 0xffff0000
    s_mov_b32 s85, 0xffff0000
    v_mov_b32 v62, 0x3f803f80
    v_mov_b32 v38, 0x3f803f80
    v_mov_b32 v39, 0x3f803f80
    v_mov_b32 v40, 0x3f803f80
    v_mov_b32 v41, 0x3f803f80
    s_waitcnt vmcnt(0)
    v_lshlrev_b32 v8, 16, v2
    v_and_b32 v9, 0xffff0000, v2
    v_lshlrev_b32 v10, 16, v3
    v_and_b32 v11, 0xffff0000, v3
    v_lshlrev_b32 v12, 16, v4
    v_and_b32 v13, 0xffff0000, v4
    v_lshlrev_b32 v14, 16, v5
    v_and_b32 v15, 0xffff0000, v5
    s_nop 1
L_setdone:
    s_mov_b32 s12, 4096
    s_mov_b32 s13, 12288
    v_lshlrev_b32 v55, 4, v21
    s_mov_b32 s48, s20
    s_mov_b32 s49, s21
    s_mov_b32 s50, 1024
    s_mov_b32 s51, 0x20000
    s_cmp_eq_u32 s3, 0
    s_cbranch_scc1 L_waitk
    s_branch L_trig
L_head:
    s_mov_b32 s43, 262144
L_pollhead:
    buffer_load_dwordx2 v[26:27], v57, s[28:31], s14 offen sc1
    s_waitcnt vmcnt(0)
    v_max_f32_dpp v28, v26, v26 quad_perm:[1,0,3,2] row_mask:0xf bank_mask:0xf
    s_nop 1
    v_max_f32_dpp v28, v28, v28 quad_perm:[2,3,0,1] row_mask:0xf bank_mask:0xf
    s_nop 1
    v_max_f32_dpp v28, v28, v28 row_half_mirror row_mask:0xf bank_mask:0xf
    v_sub_f32 v22, v26, v28
    v_mul_f32 v22, 0x3fb8aa3b, v22
    v_exp_f32 v22, v22
    s_nop 0
    v_mul_f32 v29, v22, v27
    s_nop 1
    v_add_f32_dpp v29, v29, v29 quad_perm:[1,0,3,2] row_mask:0xf bank_mask:0xf
    s_nop 1
    v_add_f32_dpp v29, v29, v29 quad_perm:[2,3,0,1] row_mask:0xf bank_mask:0xf
    s_nop 1
    v_add_f32_dpp v29, v29, v29 row_half_mirror row_mask:0xf bank_mask:0xf
    s_sub_u32 s43, s43, 1
    s_cbranch_scc1 L_pollhead_done
    v_cmp_u_f32 vcc, v29, v29
    s_cbranch_vccz L_pollhead_done
    s_sleep 32
    s_branch L_pollhead
L_pollhead_done:
    s_nop 1
    v_sub_f32 v22, v60, v28
    v_mul_f32 v22, 0x3fb8aa3b, v22
    v_exp_f32 v22, v22
    v_rcp_f32 v29, v29
    s_nop 0
    v_mul_f32 v22, v22, v29
    v_lshlrev_b32 v26, 2, v0
    s_mov_b64 exec, 15
    ds_write_b32 v26, v22 offset:7424
    s_cmp_eq_u64 s[86:87], 0
    s_cselect_b32 s40, 0, 1
    v_mov_b32 v22, s40
    ds_write_b32 v26, v22 offset:7440
    v_mov_b32 v22, 0
    ds_write_b32 v26, v22 offset:7456
    s_mov_b64 exec, -1
    s_waitcnt lgkmcnt(0)
L_trig:
    s_barrier
    s_setprio 1
    s_and_b32 s40, s27, 6
    s_cmp_eq_u32 s40, 2
    s_cbranch_scc0 L_noissC
    s_mov_b32 s42, 0
    buffer_load_dwordx4 v[128:131], v32, s[32:35], s42 offen
    s_mov_b32 s42, 57344
    buffer_load_dwordx4 v[132:135], v32, s[32:35], s42 offen
    s_mov_b32 s42, 114688
    buffer_load_dwordx4 v[136:139], v32, s[32:35], s42 offen
    s_mov_b32 s42, 172032
    buffer_load_dwordx4 v[140:143], v32, s[32:35], s42 offen
    s_mov_b32 s42, 229376
    buffer_load_dwordx4 v[144:147], v32, s[32:35], s42 offen
    s_mov_b32 s42, 286720
    buffer_load_dwordx4 v[148:151], v32, s[32:35], s42 offen
    s_mov_b32 s42, 344064
    buffer_load_dwordx4 v[152:155], v32, s[32:35], s42 offen
    s_mov_b32 s42, 401408
    buffer_load_dwordx4 v[156:159], v32, s[32:35], s42 offen
    s_mov_b32 s42, 0
    buffer_load_dwordx4 v[160:163], v33, s[4:7], s42 offen
    s_mov_b32 s42, 4096
    buffer_load_dwordx4 v[164:167], v33, s[4:7], s42 offen
    s_mov_b32 s42, 8192
    buffer_load_dwordx4 v[168:171], v33, s[4:7], s42 offen
    s_mov_b32 s42, 12288
    buffer_load_dwordx4 v[172:175], v33, s[4:7], s42 offen
    s_mov_b32 s42, 16384
    buffer_load_dwordx4 v[176:179], v33, s[4:7], s42 offen
    s_mov_b32 s42, 20480
    buffer_load_dwordx4 v[180:183], v33, s[4:7], s42 offen
    s_mov_b32 s42, 24576
    buffer_load_dwordx4 v[184:187], v33, s[4:7], s42 offen
    s_mov_b32 s42, 28672
    buffer_load_dwordx4 v[188:191], v33, s[4:7], s42 offen
L_noissC:
L_roles:
    s_mov_b32 s43, 262144
    s_cmp_lt_u32 s27, 2
    s_cbranch_scc1 L_s2pre
    s_cmp_lt_u32 s27, 4
    s_cbranch_scc1 L_s3pre
    s_cmp_eq_u32 s27, 4
    s_cbranch_scc1 L_s4pre
    s_branch L_fin
L_s2pre:
    s_barrier
L_s2:
    buffer_load_dwordx4 v[192:195], v53, s[28:31], s59 offen offset:0 sc1
    buffer_load_dwordx4 v[196:199], v53, s[28:31], s59 offen offset:64 sc1
    buffer_load_dwordx4 v[200:203], v53, s[28:31], s59 offen offset:128 sc1
    buffer_load_dwordx4 v[204:207], v53, s[28:31], s59 offen offset:192 sc1
    s_waitcnt vmcnt(3)
    v_mfma_f32_16x16x32_bf16 v[128:131], v[192:195], v[64:67], 0
    v_mfma_f32_16x16x32_bf16 v[132:135], v[192:195], v[68:71], 0
    v_mfma_f32_16x16x32_bf16 v[136:139], v[192:195], v[72:75], 0
    v_mfma_f32_16x16x32_bf16 v[140:143], v[192:195], v[76:79], 0
    s_waitcnt vmcnt(2)
    v_mfma_f32_16x16x32_bf16 v[128:131], v[196:199], v[80:83], v[128:131]
    v_mfma_f32_16x16x32_bf16 v[132:135], v[196:199], v[84:87], v[132:135]
    v_mfma_f32_16x16x32_bf16 v[136:139], v[196:199], v[88:91], v[136:139]
    v_mfma_f32_16x16x32_bf16 v[140:143], v[196:199], v[92:95], v[140:143]
    s_waitcnt vmcnt(1)
    v_mfma_f32_16x16x32_bf16 v[128:131], v[200:203], v[96:99], v[128:131]
    v_mfma_f32_16x16x32_bf16 v[132:135], v[200:203], v[100:103], v[132:135]
    v_mfma_f32_16x16x32_bf16 v[136:139], v[200:203], v[104:107], v[136:139]
    v_mfma_f32_16x16x32_bf16 v[140:143], v[200:203], v[108:111], v[140:143]
    s_waitcnt vmcnt(0)
    v_mfma_f32_16x16x32_bf16 v[128:131], v[204:207], v[112:115], v[128:131]
    v_mfma_f32_16x16x32_bf16 v[132:135], v[204:207], v[116:119], v[132:135]
    v_mfma_f32_16x16x32_bf16 v[136:139], v[204:207], v[120:123], v[136:139]
    v_mfma_f32_16x16x32_bf16 v[140:143], v[204:207], v[124:127], v[140:143]
    s_nop 4
    v_pk_add_f32 v[128:129], v[128:129], v[130:131]
    v_pk_add_f32 v[132:133], v[132:133], v[134:135]
    v_pk_add_f32 v[136:137], v[136:137], v[138:139]
    v_pk_add_f32 v[140:141], v[140:141], v[142:143]
    v_add_f32 v128, v128, v129
    v_add_f32 v132, v132, v133
    v_add_f32 v136, v136, v137
    v_add_f32 v140, v140, v141
    v_permlane16_swap_b32 v128, v132
    s_nop 0
    v_permlane16_swap_b32 v136, v140
    v_add_f32 v128, v128, v132
    v_add_f32 v136, v136, v140
    s_sub_u32 s43, s43, 1
    s_cbranch_scc1 L_s2_done
    v_cmp_u_f32 vcc, v128, v136
    s_cbranch_vccnz L_s2
L_s2_done:
    v_permlane32_swap_b32 v128, v136
    ds_write_b32 v54, v128 offset:4352
    s_waitcnt lgkmcnt(0)
    s_barrier
    s_cmp_lg_u32 s3, 0
    s_cbranch_scc1 L_end
    ds_read_b128 v[128:131], v16 offset:4352
    s_waitcnt lgkmcnt(0)
    v_add_f32 v128, v128, v129
    v_add_f32 v130, v130, v131
    v_add_f32 v24, v128, v130
    s_nop 1
    v_mov_b32_dpp v25, v24 quad_perm:[1,1,1,1] row_mask:0xf bank_mask:0xf
    v_mov_b32_dpp v26, v24 quad_perm:[2,2,2,2] row_mask:0xf bank_mask:0xf
    v_mov_b32_dpp v27, v24 quad_perm:[3,3,3,3] row_mask:0xf bank_mask:0xf
    s_mov_b32 exec_lo, 0x11111111
    s_mov_b32 exec_hi, 0x11111111
    buffer_store_dwordx4 v[24:27], v55, s[28:31], s57 offen sc1
    s_branch L_fin
L_s3pre:
    s_waitcnt vmcnt(15)
    ds_write_b128 v34, v[128:131] offset:0
    s_waitcnt vmcnt(14)
    ds_write_b128 v34, v[132:135] offset:1024
    s_waitcnt vmcnt(13)
    ds_write_b128 v34, v[136:139] offset:2048
    s_waitcnt vmcnt(12)
    ds_write_b128 v34, v[140:143] offset:3072
    s_waitcnt vmcnt(11)
    ds_write_b128 v34, v[144:147] offset:4096
    s_waitcnt vmcnt(10)
    ds_write_b128 v34, v[148:151] offset:5120
    s_waitcnt vmcnt(9)
    ds_write_b128 v34, v[152:155] offset:6144
    s_waitcnt vmcnt(8)
    ds_write_b128 v34, v[156:159] offset:7168
    s_waitcnt lgkmcnt(0)
    ds_read_b64_tr_b16 v[64:65], v35 offset:0
    ds_read_b64_tr_b16 v[66:67], v35 offset:256
    ds_read_b64_tr_b16 v[68:69], v35 offset:32
    ds_read_b64_tr_b16 v[70:71], v35 offset:288
    ds_read_b64_tr_b16 v[72:73], v35 offset:512
    ds_read_b64_tr_b16 v[74:75], v35 offset:768
    ds_read_b64_tr_b16 v[76:77], v35 offset:544
    ds_read_b64_tr_b16 v[78:79], v35 offset:800
    s_waitcnt lgkmcnt(4)
    ds_read_b64_tr_b16 v[80:81], v35 offset:1024
    ds_read_b64_tr_b16 v[82:83], v35 offset:1280
    ds_read_b64_tr_b16 v[84:85], v35 offset:1056
    ds_read_b64_tr_b16 v[86:87], v35 offset:1312
    ds_read_b64_tr_b16 v[88:89], v35 offset:1536
    ds_read_b64_tr_b16 v[90:91], v35 offset:1792
    ds_read_b64_tr_b16 v[92:93], v35 offset:1568
    ds_read_b64_tr_b16 v[94:95], v35 offset:1824
    s_waitcnt lgkmcnt(0)
    v_mfma_f32_16x16x32_bf16 v[128:131], v[38:41], v[64:67], 0
    v_mfma_f32_16x16x32_bf16 v[132:135], v[38:41], v[68:71], 0
    v_mfma_f32_16x16x32_bf16 v[128:131], v[38:41], v[72:75], v[128:131]
    v_mfma_f32_16x16x32_bf16 v[132:135], v[38:41], v[76:79], v[132:135]
    v_mfma_f32_16x16x32_bf16 v[128:131], v[38:41], v[80:83], v[128:131]
    v_mfma_f32_16x16x32_bf16 v[132:135], v[38:41], v[84:87], v[132:135]
    v_mfma_f32_16x16x32_bf16 v[128:131], v[38:41], v[88:91], v[128:131]
    v_mfma_f32_16x16x32_bf16 v[132:135], v[38:41], v[92:95], v[132:135]
    s_waitcnt vmcnt(7)
    ds_write_b128 v34, v[160:163] offset:8192
    s_waitcnt vmcnt(6)
    ds_write_b128 v34, v[164:167] offset:9216
    s_waitcnt vmcnt(5)
    ds_write_b128 v34, v[168:171] offset:10240
    s_waitcnt vmcnt(4)
    ds_write_b128 v34, v[172:175] offset:11264
    s_waitcnt vmcnt(3)
    ds_write_b128 v34, v[176:179] offset:12288
    s_waitcnt vmcnt(2)
    ds_write_b128 v34, v[180:183] offset:13312
    s_waitcnt vmcnt(1)
    ds_write_b128 v34, v[184:187] offset:14336
    s_waitcnt vmcnt(0)
    ds_write_b128 v34, v[188:191] offset:15360
    v_cndmask_b32 v128, v128, v132, s[84:85]
    s_mov_b32 exec_hi, 0
    ds_write_b32 v54, v128 offset:5376
    s_mov_b32 exec_hi, -1
    s_waitcnt lgkmcnt(0)
    ds_read_b64_tr_b16 v[96:97], v36 offset:8192
    ds_read_b64_tr_b16 v[98:99], v36 offset:9216
    ds_read_b64_tr_b16 v[100:101], v36 offset:8224
    ds_read_b64_tr_b16 v[102:103], v36 offset:9248
    ds_read_b64_tr_b16 v[104:105], v36 offset:8256
    ds_read_b64_tr_b16 v[106:107], v36 offset:9280
    ds_read_b64_tr_b16 v[108:109], v36 offset:8288
    ds_read_b64_tr_b16 v[110:111], v36 offset:9312
    s_waitcnt lgkmcnt(4)
    ds_read_b64_tr_b16 v[112:113], v36 offset:8320
    ds_read_b64_tr_b16 v[114:115], v36 offset:9344
    ds_read_b64_tr_b16 v[116:117], v36 offset:8352
    ds_read_b64_tr_b16 v[118:119], v36 offset:9376
    ds_read_b64_tr_b16 v[120:121], v36 offset:8384
    ds_read_b64_tr_b16 v[122:123], v36 offset:9408
    ds_read_b64_tr_b16 v[124:125], v36 offset:8416
    ds_read_b64_tr_b16 v[126:127], v36 offset:9440
    s_barrier
    ds_read_b128 v[140:143], v58 offset:5376
    v_mov_b32 v147, 0
    s_waitcnt lgkmcnt(0)
    v_add_f32 v140, v140, v141
    v_add_f32 v142, v142, v143
    v_add_f32 v140, v140, v142
L_s3:
    buffer_load_dwordx4 v[192:195], v53, s[28:31], s12 offen sc1
    buffer_load_dwordx4 v[196:199], v53, s[28:31], s12 offen offset:16 sc1
    buffer_load_dwordx4 v[200:203], v53, s[28:31], s13 offen sc1
    buffer_load_dwordx4 v[204:207], v53, s[28:31], s13 offen offset:16 sc1
    s_sub_u32 s43, s43, 1
    s_waitcnt vmcnt(0)
    v_pk_add_f32 v[192:193], v[192:193], v[200:201]
    v_pk_add_f32 v[194:195], v[194:195], v[202:203]
    v_pk_add_f32 v[196:197], v[196:197], v[204:205]
    v_pk_add_f32 v[198:199], v[198:199], v[206:207]
    s_cbranch_scc1 L_s3_go
    v_cmp_u_f32 vcc, v192, v196
    s_cbranch_vccnz L_s3
L_s3_go:
    v_add_f32_dpp v192, v192, v192 row_ror:8 row_mask:0xf bank_mask:0xf
    v_add_f32_dpp v193, v193, v193 row_ror:8 row_mask:0xf bank_mask:0xf
    v_add_f32_dpp v194, v194, v194 row_ror:8 row_mask:0xf bank_mask:0xf
    v_add_f32_dpp v195, v195, v195 row_ror:8 row_mask:0xf bank_mask:0xf
    v_add_f32_dpp v196, v196, v196 row_ror:8 row_mask:0xf bank_mask:0xf
    v_add_f32_dpp v197, v197, v197 row_ror:8 row_mask:0xf bank_mask:0xf
    v_add_f32_dpp v198, v198, v198 row_ror:8 row_mask:0xf bank_mask:0xf
    v_add_f32_dpp v199, v199, v199 row_ror:8 row_mask:0xf bank_mask:0xf
    v_add_f32_dpp v192, v192, v192 row_ror:4 row_mask:0xf bank_mask:0xf
    v_add_f32_dpp v193, v193, v193 row_ror:4 row_mask:0xf bank_mask:0xf
    v_add_f32_dpp v194, v194, v194 row_ror:4 row_mask:0xf bank_mask:0xf
    v_add_f32_dpp v195, v195, v195 row_ror:4 row_mask:0xf bank_mask:0xf
    v_add_f32_dpp v196, v196, v196 row_ror:4 row_mask:0xf bank_mask:0xf
    v_add_f32_dpp v197, v197, v197 row_ror:4 row_mask:0xf bank_mask:0xf
    v_add_f32_dpp v198, v198, v198 row_ror:4 row_mask:0xf bank_mask:0xf
    v_add_f32_dpp v199, v199, v199 row_ror:4 row_mask:0xf bank_mask:0xf
    v_cvt_pk_bf16_f32 v136, v192, v193
    v_cvt_pk_bf16_f32 v137, v194, v195
    v_cvt_pk_bf16_f32 v138, v196, v197
    v_cvt_pk_bf16_f32 v139, v198, v199
    v_lshlrev_b32 v128, 16, v136
    v_and_b32 v129, 0xffff0000, v136
    v_lshlrev_b32 v130, 16, v137
    v_and_b32 v131, 0xffff0000, v137
    v_lshlrev_b32 v132, 16, v138
    v_and_b32 v133, 0xffff0000, v138
    v_lshlrev_b32 v134, 16, v139
    v_and_b32 v135, 0xffff0000, v139
    v_pk_add_f32 v[128:129], v[128:129], v[8:9]
    v_pk_add_f32 v[130:131], v[130:131], v[10:11]
    v_pk_add_f32 v[132:133], v[132:133], v[12:13]
    v_pk_add_f32 v[134:135], v[134:135], v[14:15]
    v_cvt_pk_bf16_f32 v136, v128, v129
    v_cvt_pk_bf16_f32 v137, v130, v131
    v_cvt_pk_bf16_f32 v138, v132, v133
    v_cvt_pk_bf16_f32 v139, v134, v135
    v_dot2_f32_bf16 v144, v136, v62, 0
    v_dot2_f32_bf16 v145, v136, v136, 0
    v_dot2_f32_bf16 v144, v137, v62, v144
    v_dot2_f32_bf16 v145, v137, v137, v145
    v_dot2_f32_bf16 v144, v138, v62, v144
    v_dot2_f32_bf16 v145, v138, v138, v145
    v_dot2_f32_bf16 v144, v139, v62, v144
    v_dot2_f32_bf16 v145, v139, v139, v145
    v_mfma_f32_16x16x32_bf16 v[160:163], v[136:139], v[64:67], 0
    v_mfma_f32_16x16x32_bf16 v[164:167], v[136:139], v[68:71], 0
    v_mfma_f32_16x16x32_bf16 v[168:171], v[136:139], v[72:75], 0
    v_mfma_f32_16x16x32_bf16 v[172:175], v[136:139], v[76:79], 0
    v_mfma_f32_16x16x32_bf16 v[176:179], v[136:139], v[80:83], 0
    v_mfma_f32_16x16x32_bf16 v[180:183], v[136:139], v[84:87], 0
    v_mfma_f32_16x16x32_bf16 v[184:187], v[136:139], v[88:91], 0
    v_mfma_f32_16x16x32_bf16 v[188:191], v[136:139], v[92:95], 0
    v_permlane32_swap_b32 v144, v145
    v_add_f32 v144, v144, v145
    v_mov_b32 v145, v144
    s_nop 1
    v_permlane16_swap_b32 v144, v145
    v_add_f32 v144, v144, v145
    s_nop 1
    v_add_f32_dpp v144, v144, v144 quad_perm:[1,0,3,2] row_mask:0xf bank_mask:0xf
    v_add_f32 v148, v160, v169
    v_add_f32 v149, v164, v173
    v_add_f32_dpp v144, v144, v144 quad_perm:[2,3,0,1] row_mask:0xf bank_mask:0xf
    v_add_f32 v150, v178, v187
    v_add_f32 v151, v182, v191
    v_add_f32 v148, v148, v150
    v_add_f32 v149, v149, v151
    s_cbranch_scc1 L_s3_done
    v_cmp_u_f32 vcc, v144, v144
    s_cbranch_vccnz L_s3
L_s3_done:
    v_cndmask_b32 v148, v148, v149, s[84:85]
    s_mov_b32 exec_lo, 1
    s_mov_b32 exec_hi, 1
    ds_write_b32 v59, v144 offset:5888
    s_mov_b32 exec_lo, -1
    s_mov_b32 exec_hi, 0
    ds_write_b32 v54, v148 offset:4352
    s_mov_b32 exec_hi, -1
    s_waitcnt lgkmcnt(0)
    s_barrier
    ds_read_b128 v[128:131], v147 offset:5888
    ds_read_b128 v[132:135], v147 offset:5904
    ds_read_b128 v[148:151], v58 offset:4352
    s_waitcnt lgkmcnt(1)
    v_add_f32 v128, v128, v129
    v_add_f32 v130, v130, v131
    v_add_f32 v132, v132, v133
    v_add_f32 v134, v134, v135
    v_add_f32 v128, v128, v130
    v_add_f32 v132, v132, v134
    v_mul_f32 v50, 0x3b000000, v128
    v_mul_f32 v146, 0x3b000000, v132
    v_fma_f32 v146, -v50, v50, v146
    v_max_f32 v146, 0, v146
    v_cvt_pk_bf16_f32 v146, v146, v146
    v_and_b32 v146, 0xffff0000, v146
    v_add_f32 v146, 0x3727c5ac, v146
    v_cvt_pk_bf16_f32 v146, v146, v146
    v_and_b32 v146, 0xffff0000, v146
    v_sqrt_f32 v146, v146
    v_cvt_pk_bf16_f32 v50, v50, v50
    v_and_b32 v50, 0xffff0000, v50
    v_cvt_pk_bf16_f32 v146, v146, v146
    v_and_b32 v146, 0xffff0000, v146
    v_rcp_f32 v51, v146
    s_waitcnt lgkmcnt(0)
    v_add_f32 v148, v148, v149
    v_add_f32 v150, v150, v151
    v_add_f32 v148, v148, v150
    v_fma_f32 v148, -v50, v140, v148
    v_mul_f32 v148, v148, v51
    v_cvt_pk_bf16_f32 v148, v148, v148
    v_and_b32 v148, 0xffff0000, v148
    v_mul_f32 v149, 0xbfb8aa3b, v148
    v_exp_f32 v149, v149
    s_nop 0
    v_add_f32 v149, 1.0, v149
    v_rcp_f32 v149, v149
    s_nop 0
    v_mul_f32 v148, v148, v149
    s_nop 1
    v_mov_b32_dpp v149, v148 quad_perm:[1,0,3,2] row_mask:0xf bank_mask:0xf
    v_cvt_pk_bf16_f32 v148, v148, v149
    s_nop 1
    v_mov_b32_dpp v152, v148 row_newbcast:0 row_mask:0xf bank_mask:0xf
    v_mov_b32_dpp v153, v148 row_newbcast:2 row_mask:0xf bank_mask:0xf
    v_mov_b32_dpp v154, v148 row_newbcast:4 row_mask:0xf bank_mask:0xf
    v_mov_b32_dpp v155, v148 row_newbcast:6 row_mask:0xf bank_mask:0xf
    s_nop 1
    v_mfma_f32_16x16x32_bf16 v[208:211], v[152:155], v[96:99], 0
    v_mfma_f32_16x16x32_bf16 v[212:215], v[152:155], v[100:103], 0
    v_mfma_f32_16x16x32_bf16 v[216:219], v[152:155], v[104:107], 0
    v_mfma_f32_16x16x32_bf16 v[220:223], v[152:155], v[108:111], 0
    v_mfma_f32_16x16x32_bf16 v[224:227], v[152:155], v[112:115], 0
    v_mfma_f32_16x16x32_bf16 v[228:231], v[152:155], v[116:119], 0
    v_mfma_f32_16x16x32_bf16 v[232:235], v[152:155], v[120:123], 0
    v_mfma_f32_16x16x32_bf16 v[236:239], v[152:155], v[124:127], 0
    s_nop 4
    v_cndmask_b32 v46, v208, v224, s[84:85]
    v_cndmask_b32 v47, v212, v228, s[84:85]
    v_cndmask_b32 v48, v216, v232, s[84:85]
    v_cndmask_b32 v49, v220, v236, s[84:85]
    s_mov_b32 exec_hi, 0
    buffer_store_dwordx4 v[46:49], v16, s[28:31], s57 offen sc1
    s_cmp_lg_u32 s3, 0
    s_cbranch_scc1 L_end
    s_branch L_fin
L_s4pre:
    s_barrier
L_s4a:
    buffer_load_dword v128, v9, s[28:31], s12 offen sc1
    buffer_load_dword v129, v9, s[28:31], s13 offen sc1
    s_waitcnt vmcnt(0)
    v_add_f32 v128, v128, v129
    s_sub_u32 s43, s43, 1
    s_cbranch_scc1 L_s4a_done
    v_cmp_u_f32 vcc, v128, v128
    s_cbranch_vccnz L_s4a
L_s4a_done:
    s_cmp_eq_u32 s26, 0
    s_cbranch_scc0 L_noep0
    s_mov_b64 exec, 1
    s_mov_b32 s40, 466944
    buffer_store_dword v63, off, s[28:31], s40 sc1
    s_mov_b64 exec, -1
L_noep0:
    v_add_f32_dpp v128, v128, v128 row_ror:8 row_mask:0xf bank_mask:0xf
    s_nop 1
    v_add_f32_dpp v128, v128, v128 row_ror:4 row_mask:0xf bank_mask:0xf
    v_cvt_pk_bf16_f32 v128, v128, v128
    v_and_b32 v128, 0xffff0000, v128
    v_add_f32 v128, v128, v8
    v_cvt_pk_bf16_f32 v128, v128, v128
    v_and_b32 v128, 0xffff0000, v128
    s_lshl_b32 s40, s26, 6
    s_add_u32 s41, s40, 0x8000
    s_add_u32 s42, s40, 0x10000
    s_add_u32 s52, s40, 0x18000
    s_mov_b32 s43, 262144
L_s4:
    buffer_load_dwordx4 v[192:195], v53, s[32:35], s40 offen sc1
    buffer_load_dwordx4 v[196:199], v53, s[32:35], s41 offen sc1
    buffer_load_dwordx4 v[200:203], v53, s[32:35], s42 offen sc1
    buffer_load_dwordx4 v[204:207], v53, s[32:35], s52 offen sc1
    s_waitcnt vmcnt(2)
    v_pk_add_f32 v[192:193], v[192:193], v[196:197]
    v_pk_add_f32 v[194:195], v[194:195], v[198:199]
    s_waitcnt vmcnt(0)
    v_pk_add_f32 v[200:201], v[200:201], v[204:205]
    v_pk_add_f32 v[202:203], v[202:203], v[206:207]
    v_pk_add_f32 v[192:193], v[192:193], v[200:201]
    v_pk_add_f32 v[194:195], v[194:195], v[202:203]
    s_nop 0
    v_permlane16_swap_b32 v192, v193
    v_permlane16_swap_b32 v194, v195
    v_add_f32 v192, v192, v193
    v_add_f32 v194, v194, v195
    s_nop 1
    v_permlane32_swap_b32 v192, v194
    v_add_f32 v192, v192, v194
    s_nop 1
    v_add_f32_dpp v192, v192, v192 row_ror:4 row_mask:0xf bank_mask:0xf
    s_nop 1
    v_add_f32_dpp v192, v192, v192 row_ror:8 row_mask:0xf bank_mask:0xf
    s_sub_u32 s43, s43, 1
    s_cbranch_scc1 L_s4_done
    v_cmp_u_f32 vcc, v192, v192
    s_cbranch_vccnz L_s4
L_s4_done:
    v_cvt_pk_bf16_f32 v192, v192, v192
    v_and_b32 v192, 0xffff0000, v192
    v_add_f32 v192, v192, v128
    v_cvt_pk_bf16_f32 v192, v192, v192
    s_mov_b32 exec_lo, 0x000f000f
    s_mov_b32 exec_hi, 0x000f000f
    buffer_store_short v192, v54, s[48:51], 0 offen
L_noep:
L_fin:
L_end:
    s_endpgm
L_codeend:
.section .rodata,"a"
.p2align 6
.amdhsa_kernel sequential_preLN__mha_block_cached__dense_activation_silu__decode_kernel
  .amdhsa_next_free_vgpr 256
  .amdhsa_next_free_sgpr 96
  .amdhsa_accum_offset 256
  .amdhsa_group_segment_fixed_size 0
  .amdhsa_kernarg_size 88
  .amdhsa_user_sgpr_count 2
  .amdhsa_user_sgpr_kernarg_segment_ptr 1
  .amdhsa_system_sgpr_workgroup_id_x 1
.end_amdhsa_kernel
```
